```python
import torch

def _softmax(x, axis=-1):
    return torch.softmax(x, dim=axis)
def _gelu(x):
    return torch.nn.functional.gelu(x, approximate="tanh")
def _silu(x):
    return torch.nn.functional.silu(x)
def _sigmoid(x):
    return torch.sigmoid(x)
def _layernorm(x, axis=-1, eps=1e-5):
    m = x.mean(dim=axis, keepdim=True)
    v = x.var(dim=axis, keepdim=True, unbiased=False)
    return (x - m) / torch.sqrt(v + eps)
def _scatter_add(tgt, idx, src, axis=0):
    return tgt.clone().index_add_(axis, idx, src)
def _segment_sum(src, seg, n):
    out = torch.zeros((n,) + src.shape[1:], dtype=src.dtype)
    return out.index_add_(0, seg, src)
def _pad(x, pw):
    flat = tuple(v for pair in reversed(pw) for v in pair)
    return torch.nn.functional.pad(x, flat)

kernel_name = 'recurrent_scan__ssm_conv_s5__glu_gated_bilinear__prompt'

def setup_inputs():

    _w = (lambda a: (lambda t: t.to(torch.bfloat16) if t.is_floating_point() else t)(torch.as_tensor(a)))
    def _A_setup():
        B, S, D = 1, 2048, 448
        P = D
        Lambda_re = -0.5 * (lambda _x: torch.exp(torch.as_tensor(_x)))((lambda *s: torch.randn(*s, dtype=torch.bfloat16) * 0.8)(P))
        Lambda_im = (lambda *s: torch.randn(*s, dtype=torch.bfloat16) * 0.8)(P) * 1.0
        B_re = (lambda *s: torch.randn(*s, dtype=torch.bfloat16) * 1.6)(P, D) * (D ** -0.5)
        B_im = (lambda *s: torch.randn(*s, dtype=torch.bfloat16) * 1.6)(P, D) * (D ** -0.5)
        C_re = (lambda *s: torch.randn(*s, dtype=torch.bfloat16) * 1.6)(D, P) * (P ** -0.5)
        C_im = (lambda *s: torch.randn(*s, dtype=torch.bfloat16) * 1.6)(D, P) * (P ** -0.5)
        log_dt = (lambda *s: torch.randn(*s, dtype=torch.bfloat16) * 0.8)(P) * 0.3 - 2.0
        Dskip = (lambda *s: torch.randn(*s, dtype=torch.bfloat16) * 0.8)(D)
        return {
            "x": _w((lambda *s: torch.randn(*s, dtype=torch.bfloat16) * 0.05)(B, S, D)),
            "Lambda_re": _w(Lambda_re),
            "Lambda_im": _w(Lambda_im),
            "B_re": _w(B_re),
            "B_im": _w(B_im),
            "C_re": _w(C_re),
            "C_im": _w(C_im),
            "log_dt": _w(log_dt),
            "Dskip": _w(Dskip),
        }
    _A_in = _A_setup()

    def _B_setup():
        B, S, D, F = 1, 2048, 448, 1792
        return {
            "x": _w((lambda *s: torch.randn(*s, dtype=torch.bfloat16) * 0.05)(B, S, D)),
            "w_gate": _w((lambda *s: torch.randn(*s, dtype=torch.bfloat16) * 0.2)(D, F) * (D ** -0.5)),
            "w_up": _w((lambda *s: torch.randn(*s, dtype=torch.bfloat16) * 0.2)(D, F) * (D ** -0.5)),
            "w_down": _w((lambda *s: torch.randn(*s, dtype=torch.bfloat16) * 0.2)(F, D) * (F ** -0.5)),
        }
    _B_in = _B_setup()

    return {
        "A_x": _A_in["x"],
        "A_Lambda_re": _A_in["Lambda_re"],
        "A_Lambda_im": _A_in["Lambda_im"],
        "A_B_re": _A_in["B_re"],
        "A_B_im": _A_in["B_im"],
        "A_C_re": _A_in["C_re"],
        "A_C_im": _A_in["C_im"],
        "A_log_dt": _A_in["log_dt"],
        "A_Dskip": _A_in["Dskip"],
        "B_x": _B_in["x"],
        "B_w_gate": _B_in["w_gate"],
        "B_w_up": _B_in["w_up"],
        "B_w_down": _B_in["w_down"],
    }

def reference(A_x, A_Lambda_re, A_Lambda_im, A_B_re, A_B_im, A_C_re, A_C_im, A_log_dt, A_Dskip, B_x, B_w_gate, B_w_up, B_w_down):
    def _A_ref(x, Lambda_re, Lambda_im, B_re, B_im, C_re, C_im, log_dt, Dskip):
        Bsz, L, H = x.shape
        Lam = Lambda_re + 1j * Lambda_im
        Bmat = B_re + 1j * B_im
        Cmat = C_re + 1j * C_im
        dt = torch.exp(log_dt)
        Lam_bar = torch.exp(dt * Lam)
        B_bar = ((Lam_bar - 1.0) / Lam)[:, None] * Bmat
        Bu = torch.einsum("bld,pd->blp", x + 0j, B_bar)
        h = torch.zeros_like(Bu[:, 0, :])
        hs = []
        for t in range(L):
            h = Lam_bar[None, :] * h + Bu[:, t, :]
            hs.append(h)
        hseq = torch.stack(hs, 1)
        y = 2.0 * torch.einsum("blp,dp->bld", hseq, Cmat).real + x * Dskip[None, None, :]
        return y

    def _B_ref(x, w_gate, w_up, w_down):
        g = torch.einsum("bsd,df->bsf", x, w_gate)
        u = torch.einsum("bsd,df->bsf", x, w_up)
        h = g * u
        return torch.einsum("bsf,fd->bsd", h, w_down)

    x = A_x
    xn = _layernorm(x, axis=-1)
    s = _A_ref(xn, A_Lambda_re, A_Lambda_im, A_B_re, A_B_im, A_C_re, A_C_im, A_log_dt, A_Dskip)
    g = _silu(_B_ref(xn, B_w_gate, B_w_up, B_w_down))
    return x + s * g
```

```asm
; @launch grid=(256,1,1) block=(512,1,1) lds=163840
.amdgcn_target "amdgcn-amd-amdhsa--gfx950"
.text
.globl recurrent_scan__ssm_conv_s5__glu_gated_bilinear__prompt_kernel
.p2align 8
.type recurrent_scan__ssm_conv_s5__glu_gated_bilinear__prompt_kernel,@function
recurrent_scan__ssm_conv_s5__glu_gated_bilinear__prompt_kernel:
    s_cmpk_ge_u32 s2, 256
    s_cbranch_scc1 L_end
    s_load_dwordx16 s[16:31], s[0:1], 0
    s_load_dwordx16 s[32:47], s[0:1], 64
    v_lshrrev_b32 v6, 6, v0
    v_and_b32 v1, 63, v0
    s_getpc_b64 s[88:89]
    v_readfirstlane_b32 s3, v6
    s_lshr_b32 s10, s2, 3
    s_and_b32 s14, s10, 3
    v_lshrrev_b32 v7, 3, v0
    v_lshl_add_u32 v7, v7, 2, s14
    v_lshlrev_b32 v7, 7, v7
    global_load_dword v249, v7, s[88:89]
    s_and_b32 s5, s2, 6
    s_lshl1_add_u32 s5, s5, s14
    s_lshr_b32 s8, s10, 2
    s_sub_u32 s8, s8, 1
    v_lshrrev_b32 v6, 3, v1
    v_and_b32 v7, 7, v1
    v_lshrrev_b32 v8, 4, v1
    v_xor_b32 v9, v7, v8
    v_lshlrev_b32 v9, 4, v9
    v_xor_b32 v11, 64, v9
    s_and_b32 s4, s3, 3
    s_and_b32 s9, s2, 7
    s_cmp_lt_u32 s10, 4
    s_cbranch_scc1 L_helper
    s_lshl1_add_u32 s15, s14, s8
    s_cmp_ge_u32 s15, 7
    s_cselect_b32 s12, 7, 0
    s_sub_u32 s80, s15, s12
    s_lshl_b32 s97, s4, 12
    s_lshr_b32 s95, s3, 2
    s_cmp_eq_u32 s95, 1
    s_cbranch_scc1 L_pad
    v_and_b32 v10, 3, v6
    v_lshrrev_b32 v12, 2, v6
    v_lshl_add_u32 v13, v12, 4, v10
    v_mul_u32_u24 v13, 896, v13
    v_add_u32 v128, v13, v9
    v_add_u32 v129, v13, v11
    s_lshl2_add_u32 s12, s5, s4
    s_mulk_i32 s12, 28672
    s_sub_u32 s50, 1835008, s12
    s_mov_b32 s51, 0x20000
    s_waitcnt lgkmcnt(0)
    s_add_u32 s48, s16, s12
    s_addc_u32 s49, s17, 0
    s_add_u32 m0, s97, 0
    s_lshl_b32 s88, s80, 7
    buffer_load_dwordx4 v128, s[48:51], s88 offen  lds
    s_addk_i32 s88, 2560
    buffer_load_dwordx4 v129, s[48:51], s88 offen offset:1024  lds
    s_addk_i32 s88, 2560
    buffer_load_dwordx4 v128, s[48:51], s88 offen offset:2048  lds
    s_addk_i32 s88, 2560
    buffer_load_dwordx4 v129, s[48:51], s88 offen offset:3072  lds
    s_branch L_nopad
L_pad:
    s_branch L_shead
L_nopad:
    s_and_b32 s15, s9, 1
    s_mul_i32 s15, s15, 7
    s_add_u32 s6, s15, s8
    s_lshl_b32 s94, s4, 11
    v_lshl_add_u32 v13, v12, 3, v10
    v_mul_u32_u24 v13, 896, v13
    v_add_u32 v130, v13, v9
    v_add_u32 v131, v13, v11
    s_and_b32 s13, s4, 1
    s_lshl1_add_u32 s13, s6, s13
    s_mul_i32 s13, s13, 14336
    s_cmp_ge_u32 s4, 2
    s_cselect_b32 s52, s24, s22
    s_cselect_b32 s53, s25, s23
    s_add_u32 s52, s52, s13
    s_addc_u32 s53, s53, 0
    s_and_b32 s53, s53, 0xffff
    s_sub_u32 s54, 401408, s13
    s_mov_b32 s55, 0x20000
    s_add_u32 m0, s94, 139264
    s_lshl_b32 s88, s80, 7
    buffer_load_dwordx4 v130, s[52:55], s88 offen  lds
    s_addk_i32 s88, 2560
    buffer_load_dwordx4 v131, s[52:55], s88 offen offset:1024  lds
    s_mov_b32 s95, 0
    s_branch L_common
L_shead:
    s_mov_b32 s95, 1
    s_and_b32 s15, s9, 1
    s_mul_i32 s15, s15, 7
    s_add_u32 s6, s15, s8
    v_and_b32 v12, 0x13, v1
    v_bfe_u32 v13, v1, 2, 1
    v_lshl_or_b32 v12, v13, 3, v12
    v_bfe_u32 v13, v1, 3, 1
    v_lshl_or_b32 v3, v13, 2, v12
    s_lshl_b32 s14, s6, 5
    v_add_lshl_u32 v14, v3, s14, 1
    s_lshl_b32 s12, s4, 3
    v_add_u32 v245, s12, v6
    v_min_u32 v245, 18, v245
    s_mul_i32 s12, s8, 19
    v_add_u32 v245, s12, v245
    v_min_u32 v245, 127, v245
    s_lshl_b32 s12, s5, 7
    v_add_u32 v245, s12, v245
    v_mul_u32_u24 v244, 896, v245
    v_lshl_add_u32 v244, v7, 4, v244
    s_waitcnt lgkmcnt(0)
    s_setprio 1
    s_cmp_eq_u32 s4, 3
    s_cbranch_scc1 L_norow
    global_load_dwordx4 v[128:131], v244, s[16:17] offset:0
    global_load_dwordx4 v[132:135], v244, s[16:17] offset:128
    global_load_dwordx4 v[136:139], v244, s[16:17] offset:256
    global_load_dwordx4 v[140:143], v244, s[16:17] offset:384
    global_load_dwordx4 v[144:147], v244, s[16:17] offset:512
    global_load_dwordx4 v[148:151], v244, s[16:17] offset:640
    global_load_dwordx4 v[152:155], v244, s[16:17] offset:768
L_norow:
    v_mov_b32 v248, v14
L_common:
    s_add_u32 s34, s46, 12124160
    s_addc_u32 s35, s47, 0
    s_load_dword s11, s[34:35], 0
    s_add_u32 s81, s80, 1
    s_cmp_eq_u32 s81, 7
    s_cselect_b32 s81, 0, s81
    s_add_u32 s82, s81, 1
    s_cmp_eq_u32 s82, 7
    s_cselect_b32 s82, 0, s82
    s_add_u32 s83, s82, 1
    s_cmp_eq_u32 s83, 7
    s_cselect_b32 s83, 0, s83
    s_add_u32 s84, s83, 1
    s_cmp_eq_u32 s84, 7
    s_cselect_b32 s84, 0, s84
    s_add_u32 s85, s84, 1
    s_cmp_eq_u32 s85, 7
    s_cselect_b32 s85, 0, s85
    s_add_u32 s86, s85, 1
    s_cmp_eq_u32 s86, 7
    s_cselect_b32 s86, 0, s86
    s_and_b32 s14, s10, 3
    s_lshl2_add_u32 s7, s9, s14
    s_mov_b32 s96, 0x3f803f80
    v_lshrrev_b32 v13, 5, v1
    v_bfe_u32 v8, v1, 1, 3
    v_xor_b32 v13, v13, v8
    v_lshlrev_b32 v13, 4, v13
    v_and_b32 v12, 31, v1
    v_lshl_add_u32 v5, v12, 7, v13
    v_bfe_u32 v13, v1, 4, 1
    s_and_b32 s12, s4, 2
    v_add_u32 v8, s12, v13
    v_lshlrev_b32 v8, 1, v8
    v_xor_b32 v8, v8, v7
    v_lshlrev_b32 v8, 4, v8
    v_mul_u32_u24 v10, 3584, v6
    v_add_u32 v10, v10, v8
    s_lshl_b32 s12, s6, 8
    s_and_b32 s14, s4, 1
    s_mul_i32 s13, s14, 114688
    s_add_u32 s12, s12, s13
    s_cmp_ge_u32 s4, 2
    s_cselect_b32 s56, s38, s36
    s_cselect_b32 s57, s39, s37
    s_add_u32 s56, s56, s12
    s_addc_u32 s57, s57, 0
    s_and_b32 s57, s57, 0xffff
    s_sub_u32 s58, 1605632, s12
    s_mov_b32 s59, 0x20000
    s_lshl_b32 s87, s5, 2
    s_add_u32 s87, s87, s4
    s_mul_i32 s15, s87, 56
    s_lshl_b32 s87, s87, 7
    s_lshl_b32 s13, s6, 2
    s_add_u32 s87, s87, s13
    s_lshl_b32 s87, s87, 6
    s_add_u32 s87, s87, 12582912
    v_mul_u32_u24 v237, 896, v6
    v_lshlrev_b32 v8, 2, v13
    v_xor_b32 v8, v8, v7
    v_lshl_add_u32 v237, v8, 4, v237
    s_lshr_b32 s12, s4, 1
    s_mul_i32 s12, s12, 28
    s_add_u32 s12, s12, s14
    s_mul_i32 s12, s12, 28672
    s_lshl_b32 s89, s8, 7
    s_add_u32 s12, s12, s89
    s_add_u32 s64, s40, s12
    s_addc_u32 s65, s41, 0
    s_and_b32 s65, s65, 0xffff
    s_sub_u32 s66, 1605632, s12
    s_mov_b32 s67, 0x20000
    s_mov_b32 s68, s46
    s_and_b32 s69, s47, 0xffff
    s_mov_b32 s70, 14680064
    s_mov_b32 s71, 0x20000
    s_mov_b32 s72, s42
    s_and_b32 s73, s43, 0xffff
    s_mov_b32 s74, 3670016
    s_mov_b32 s75, 0x20000
    s_mov_b32 s76, s16
    s_and_b32 s77, s17, 0xffff
    s_mov_b32 s78, 1835008
    s_mov_b32 s79, 0x20000
    s_cmp_eq_u32 s95, 0
    s_cbranch_scc1 L_grole
    s_add_u32 s15, s15, s13
    s_lshl_b32 s15, s15, 10
    v_mul_u32_u24 v2, 896, v6
    v_add_u32 v6, v2, v9
    v_add_u32 v7, v2, v11
    v_mov_b32 v9, v237
    v_lshrrev_b32 v8, 5, v1
    s_lshl_b32 s12, s4, 1
    v_add_u32 v8, s12, v8
    v_add_u32 v11, s97, v5
    s_lshl_b32 s12, s4, 5
    v_xor_b32 v4, s12, v5
    s_lshl_b32 s12, s8, 1
    s_add_u32 s12, s12, s14
    s_mul_i32 s12, s12, 28672
    s_cmp_ge_u32 s4, 2
    s_cselect_b32 s60, s28, s26
    s_cselect_b32 s61, s29, s27
    s_add_u32 s60, s60, s12
    s_addc_u32 s61, s61, 0
    s_and_b32 s61, s61, 0xffff
    s_sub_u32 s62, 401408, s12
    s_mov_b32 s63, 0x20000
    v_lshlrev_b32 v13, 3, v3
    s_lshl_b32 s14, s6, 8
    s_add_u32 s14, s14, 12255232
    v_mov_b32 v122, 0
    v_mov_b32 v123, 0
    v_mov_b32 v126, 0
    v_mov_b32 v127, 0
    v_mov_b32 v209, 0
    v_mov_b32 v210, 0
    v_mov_b32 v211, 0
    v_lshlrev_b32 v212, 6, v8
    v_add_u32 v212, 156160, v212
    s_lshl_b32 s12, s4, 7
    s_add_u32 s12, s12, 155648
    v_lshl_add_u32 v213, v12, 2, s12
    v_lshlrev_b32 v214, 3, v12
    v_add_u32 v214, 159744, v214
    v_mov_b32 v215, v214
    v_lshl_add_u32 v214, v8, 8, v214
    v_lshlrev_b32 v247, 1, v8
    v_cmp_eq_u32 vcc, 7, v8
    v_lshlrev_b32 v253, 4, v8
    v_cvt_f32_u32 v253, v253
    s_mov_b32 s12, 11534336
    s_add_u32 s52, s46, s12
    s_addc_u32 s53, s47, 0
    s_and_b32 s53, s53, 0xffff
    s_sub_u32 s54, 11649024, s12
    s_mov_b32 s55, 0x20000
    s_mul_i32 s12, s5, 14
    s_add_u32 s12, s12, s6
    s_lshl_b32 s12, s12, 9
    v_lshl_add_u32 v14, v12, 4, s12
    v_lshlrev_b32 v12, 4, v1
    s_lshl_b32 s12, s4, 8
    s_add_u32 s12, s12, 157696
    v_lshl_add_u32 v252, v1, 2, s12
    v_add_u32 v8, 1024, v252
    s_waitcnt lgkmcnt(0)
    s_mul_i32 s11, s11, 1664525
    s_add_u32 s11, s11, 1013904223
    v_add_u32 v224, 1, v247
    v_mul_u32_u24 v224, 7168, v224
    v_sub_u32 v232, v14, v224
    v_cndmask_b32 v14, -1, v14, vcc
    v_subrev_u32 v233, 7168, v232
    v_sub_u32 v255, s5, v247
    v_med3_i32 v255, v255, 0, 2
    v_lshlrev_b32 v255, 1, v255
    v_mul_lo_u32 v224, v255, s11
    v_mul_f32 v247, 0x41800000, v253
    v_min_u32 v225, 27, v1
    v_cmp_lt_u32 vcc, 13, v225
    v_lshlrev_b32 v225, 2, v225
    v_add_u32 v255, 72, v225
    v_cndmask_b32 v225, v225, v255, vcc
    s_lshl_b32 s90, s7, 14
    s_add_u32 s90, s90, 12582912
    v_lshlrev_b32 v225, 6, v225
    s_lshl_b32 s91, s7, 1
    s_mul_i32 s91, s91, 56
    s_lshl_b32 s12, s4, 1
    s_add_u32 s91, s91, s12
    s_lshl_b32 s91, s91, 10
    v_lshlrev_b32 v242, 3, v1
    s_and_b32 s12, s4, 1
    s_mul_i32 s92, s12, 14
    s_add_u32 s92, s92, s6
    s_lshl_b32 s92, s92, 10
    s_add_u32 s92, s92, 12189696
    s_lshl_b32 s12, s12, 9
    s_add_u32 s12, s12, 156672
    v_lshl_add_u32 v243, v1, 2, s12
    v_and_b32 v188, 1, v1
    v_lshlrev_b32 v188, 4, v188
    v_mov_b32 v189, 0x3f80
    v_lshlrev_b32 v188, v188, v189
    v_bfe_u32 v189, v1, 1, 4
    v_lshrrev_b32 v190, 5, v1
    v_lshlrev_b32 v190, 3, v190
    v_sub_u32 v189, v189, v190
    v_cmp_eq_u32 vcc, 0, v189
    s_nop 1
    v_cndmask_b32 v176, 0, v188, vcc
    v_cmp_eq_u32 vcc, 1, v189
    s_nop 1
    v_cndmask_b32 v177, 0, v188, vcc
    v_cmp_eq_u32 vcc, 2, v189
    s_nop 1
    v_cndmask_b32 v178, 0, v188, vcc
    v_cmp_eq_u32 vcc, 3, v189
    s_nop 1
    v_cndmask_b32 v179, 0, v188, vcc
    v_cmp_eq_u32 vcc, 4, v189
    s_nop 1
    v_cndmask_b32 v180, 0, v188, vcc
    v_cmp_eq_u32 vcc, 5, v189
    s_nop 1
    v_cndmask_b32 v181, 0, v188, vcc
    v_cmp_eq_u32 vcc, 6, v189
    s_nop 1
    v_cndmask_b32 v182, 0, v188, vcc
    v_cmp_eq_u32 vcc, 7, v189
    s_nop 1
    v_cndmask_b32 v183, 0, v188, vcc
    v_lshlrev_b32 v245, 4, v245
    v_bfe_u32 v244, v1, 3, 2
    v_and_b32 v246, 3, v1
    v_lshl_add_u32 v244, v244, 2, v246
    v_bfe_u32 v246, v1, 2, 1
    v_lshl_add_u32 v244, v246, 4, v244
    s_lshl2_add_u32 s12, s5, s4
    s_lshl_b32 s12, s12, 5
    v_add_lshl_u32 v244, v244, s12, 4
    s_mov_b32 s93, 11796480
    v_mov_b32 v220, s96
    v_mov_b32 v221, s96
    v_mov_b32 v222, s96
    v_mov_b32 v223, s96
    ds_write_b32 v252, v209 offset:0
    ds_write_b32 v252, v209 offset:1024
    ds_write_b32 v252, v209 offset:2048
    ds_write_b32 v252, v209 offset:3072
    s_cmp_eq_u32 s4, 3
    s_cbranch_scc1 L_nostat
    s_waitcnt vmcnt(6)
    v_dot2_f32_bf16 v192, v128, s96, 0
    v_dot2_f32_bf16 v200, v128, v128, 0
    v_dot2_f32_bf16 v193, v129, s96, 0
    v_dot2_f32_bf16 v201, v129, v129, 0
    v_dot2_f32_bf16 v194, v130, s96, 0
    v_dot2_f32_bf16 v202, v130, v130, 0
    v_dot2_f32_bf16 v195, v131, s96, 0
    v_dot2_f32_bf16 v203, v131, v131, 0
    s_waitcnt vmcnt(5)
    v_dot2_f32_bf16 v196, v132, s96, 0
    v_dot2_f32_bf16 v204, v132, v132, 0
    v_dot2_f32_bf16 v197, v133, s96, 0
    v_dot2_f32_bf16 v205, v133, v133, 0
    v_dot2_f32_bf16 v198, v134, s96, 0
    v_dot2_f32_bf16 v206, v134, v134, 0
    v_dot2_f32_bf16 v199, v135, s96, 0
    v_dot2_f32_bf16 v207, v135, v135, 0
    s_waitcnt vmcnt(4)
    v_dot2_f32_bf16 v192, v136, s96, v192
    v_dot2_f32_bf16 v200, v136, v136, v200
    v_dot2_f32_bf16 v193, v137, s96, v193
    v_dot2_f32_bf16 v201, v137, v137, v201
    v_dot2_f32_bf16 v194, v138, s96, v194
    v_dot2_f32_bf16 v202, v138, v138, v202
    v_dot2_f32_bf16 v195, v139, s96, v195
    v_dot2_f32_bf16 v203, v139, v139, v203
    s_waitcnt vmcnt(3)
    v_dot2_f32_bf16 v196, v140, s96, v196
    v_dot2_f32_bf16 v204, v140, v140, v204
    v_dot2_f32_bf16 v197, v141, s96, v197
    v_dot2_f32_bf16 v205, v141, v141, v205
    v_dot2_f32_bf16 v198, v142, s96, v198
    v_dot2_f32_bf16 v206, v142, v142, v206
    v_dot2_f32_bf16 v199, v143, s96, v199
    v_dot2_f32_bf16 v207, v143, v143, v207
    s_waitcnt vmcnt(2)
    v_dot2_f32_bf16 v192, v144, s96, v192
    v_dot2_f32_bf16 v200, v144, v144, v200
    v_dot2_f32_bf16 v193, v145, s96, v193
    v_dot2_f32_bf16 v201, v145, v145, v201
    v_dot2_f32_bf16 v194, v146, s96, v194
    v_dot2_f32_bf16 v202, v146, v146, v202
    v_dot2_f32_bf16 v195, v147, s96, v195
    v_dot2_f32_bf16 v203, v147, v147, v203
    s_waitcnt vmcnt(1)
    v_dot2_f32_bf16 v196, v148, s96, v196
    v_dot2_f32_bf16 v204, v148, v148, v204
    v_dot2_f32_bf16 v197, v149, s96, v197
    v_dot2_f32_bf16 v205, v149, v149, v205
    v_dot2_f32_bf16 v198, v150, s96, v198
    v_dot2_f32_bf16 v206, v150, v150, v206
    v_dot2_f32_bf16 v199, v151, s96, v199
    v_dot2_f32_bf16 v207, v151, v151, v207
    s_waitcnt vmcnt(0)
    v_dot2_f32_bf16 v192, v152, s96, v192
    v_dot2_f32_bf16 v200, v152, v152, v200
    v_dot2_f32_bf16 v193, v153, s96, v193
    v_dot2_f32_bf16 v201, v153, v153, v201
    v_dot2_f32_bf16 v194, v154, s96, v194
    v_dot2_f32_bf16 v202, v154, v154, v202
    v_dot2_f32_bf16 v195, v155, s96, v195
    v_dot2_f32_bf16 v203, v155, v155, v203
    v_add_f32 v192, v192, v196
    v_add_f32 v200, v200, v204
    v_add_f32 v193, v193, v197
    v_add_f32 v201, v201, v205
    v_add_f32 v194, v194, v198
    v_add_f32 v202, v202, v206
    v_add_f32 v195, v195, v199
    v_add_f32 v203, v203, v207
    v_add_f32 v192, v192, v194
    v_add_f32 v200, v200, v202
    v_add_f32 v193, v193, v195
    v_add_f32 v201, v201, v203
    v_add_f32 v192, v192, v193
    v_add_f32 v200, v200, v201
    s_nop 1
    v_add_f32_dpp v192, v192, v192 quad_perm:[1,0,3,2] row_mask:0xf bank_mask:0xf
    v_add_f32_dpp v200, v200, v200 quad_perm:[1,0,3,2] row_mask:0xf bank_mask:0xf
    s_nop 1
    v_add_f32_dpp v192, v192, v192 quad_perm:[2,3,0,1] row_mask:0xf bank_mask:0xf
    v_add_f32_dpp v200, v200, v200 quad_perm:[2,3,0,1] row_mask:0xf bank_mask:0xf
    s_nop 1
    v_add_f32_dpp v192, v192, v192 row_half_mirror row_mask:0xf bank_mask:0xf
    v_add_f32_dpp v200, v200, v200 row_half_mirror row_mask:0xf bank_mask:0xf
    v_mul_f32 v192, 0x3b124925, v192
    v_mul_f32 v200, 0x3b124925, v200
    v_cvt_pk_bf16_f32 v196, -v192, -v192
    v_fma_f32 v200, -v192, v192, v200
    v_max_f32 v200, 0, v200
    v_cvt_pk_bf16_f32 v200, v200, v200
    v_and_b32 v200, 0xffff0000, v200
    v_add_f32 v200, 0x3727c5ac, v200
    v_cvt_pk_bf16_f32 v200, v200, v200
    v_and_b32 v200, 0xffff0000, v200
    v_sqrt_f32 v200, v200
    v_mov_b32 v197, s11
    v_cvt_pk_bf16_f32 v200, v200, v200
    v_and_b32 v200, 0xffff0000, v200
    v_rcp_f32 v198, v200
    v_mov_b32 v199, s11
    s_mov_b32 s12, 11796480
    s_mov_b32 exec_lo, 0x01010101
    s_mov_b32 exec_hi, 0x01010101
    buffer_store_dwordx4 v[196:199], v245, s[68:71], s12 offen sc1
    s_mov_b64 exec, -1
L_nostat:
    v_add_u32 v112, 0, v11
    v_add_u32 v116, 139264, v5
    v_xor_b32 v113, 32, v112
    v_xor_b32 v117, 32, v116
    v_xor_b32 v114, 64, v112
    v_xor_b32 v118, 64, v116
    v_xor_b32 v115, 96, v112
    v_xor_b32 v119, 96, v116
    s_waitcnt lgkmcnt(0)
    s_barrier
    ds_read_b128 v[16:19], v112
    ds_read_b128 v[20:23], v116
    ds_read_b128 v[24:27], v116 offset:4096
    ds_read_b128 v[28:31], v113
    ds_read_b128 v[32:35], v117
    ds_read_b128 v[36:39], v117 offset:4096
    ds_read_b128 v[40:43], v114
    ds_read_b128 v[44:47], v118
    ds_read_b128 v[48:51], v118 offset:4096
    ds_read_b128 v[52:55], v115
    ds_read_b128 v[56:59], v119
    ds_read_b128 v[60:63], v119 offset:4096
    v_add_u32 v112, 16384, v11
    v_add_u32 v116, 147456, v5
    v_xor_b32 v113, 32, v112
    v_xor_b32 v117, 32, v116
    v_xor_b32 v114, 64, v112
    v_xor_b32 v118, 64, v116
    v_xor_b32 v115, 96, v112
    v_xor_b32 v119, 96, v116
    global_load_ushort v184, v248, s[18:19]
    global_load_ushort v185, v248, s[20:21]
    global_load_ushort v186, v248, s[30:31]
    s_waitcnt lgkmcnt(0)
    v_mfma_f32_32x32x16_bf16 v[128:143], v[16:19], v[20:23], 0
    ds_read_b128 v[64:67], v112
    ds_read_b128 v[68:71], v116
    v_mfma_f32_32x32x16_bf16 v[144:159], v[16:19], v[24:27], 0
    ds_read_b128 v[72:75], v116 offset:4096
    ds_read_b128 v[76:79], v113
    v_mfma_f32_32x32x16_bf16 v[128:143], v[28:31], v[32:35], v[128:143]
    ds_read_b128 v[80:83], v117
    ds_read_b128 v[84:87], v117 offset:4096
    v_mfma_f32_32x32x16_bf16 v[144:159], v[28:31], v[36:39], v[144:159]
    ds_read_b128 v[88:91], v114
    ds_read_b128 v[92:95], v118
    v_mfma_f32_32x32x16_bf16 v[128:143], v[40:43], v[44:47], v[128:143]
    ds_read_b128 v[96:99], v118 offset:4096
    ds_read_b128 v[100:103], v115
    v_mfma_f32_32x32x16_bf16 v[144:159], v[40:43], v[48:51], v[144:159]
    ds_read_b128 v[104:107], v119
    ds_read_b128 v[108:111], v119 offset:4096
    v_mfma_f32_32x32x16_bf16 v[128:143], v[52:55], v[56:59], v[128:143]
    v_mfma_f32_32x32x16_bf16 v[144:159], v[52:55], v[60:63], v[144:159]
    v_add_u32 v112, 32768, v11
    v_add_u32 v116, 114688, v5
    v_xor_b32 v113, 32, v112
    v_xor_b32 v117, 32, v116
    v_xor_b32 v114, 64, v112
    v_xor_b32 v118, 64, v116
    v_xor_b32 v115, 96, v112
    v_xor_b32 v119, 96, v116
    s_waitcnt lgkmcnt(0)
    s_barrier
    v_mfma_f32_32x32x16_bf16 v[128:143], v[64:67], v[68:71], v[128:143]
    ds_read_b128 v[16:19], v112
    ds_read_b128 v[20:23], v116
    v_mfma_f32_32x32x16_bf16 v[144:159], v[64:67], v[72:75], v[144:159]
    ds_read_b128 v[24:27], v116 offset:4096
    ds_read_b128 v[28:31], v113
    v_mfma_f32_32x32x16_bf16 v[128:143], v[76:79], v[80:83], v[128:143]
    ds_read_b128 v[32:35], v117
    ds_read_b128 v[36:39], v117 offset:4096
    v_mfma_f32_32x32x16_bf16 v[144:159], v[76:79], v[84:87], v[144:159]
    ds_read_b128 v[40:43], v114
    ds_read_b128 v[44:47], v118
    v_mfma_f32_32x32x16_bf16 v[128:143], v[88:91], v[92:95], v[128:143]
    ds_read_b128 v[48:51], v118 offset:4096
    ds_read_b128 v[52:55], v115
    v_mfma_f32_32x32x16_bf16 v[144:159], v[88:91], v[96:99], v[144:159]
    ds_read_b128 v[56:59], v119
    ds_read_b128 v[60:63], v119 offset:4096
    v_mfma_f32_32x32x16_bf16 v[128:143], v[100:103], v[104:107], v[128:143]
    v_mfma_f32_32x32x16_bf16 v[144:159], v[100:103], v[108:111], v[144:159]
    v_add_u32 v112, 49152, v11
    v_add_u32 v116, 122880, v5
    v_xor_b32 v113, 32, v112
    v_xor_b32 v117, 32, v116
    v_xor_b32 v114, 64, v112
    v_xor_b32 v118, 64, v116
    v_xor_b32 v115, 96, v112
    v_xor_b32 v119, 96, v116
    s_waitcnt lgkmcnt(0)
    s_barrier
    v_mfma_f32_32x32x16_bf16 v[128:143], v[16:19], v[20:23], v[128:143]
    ds_read_b128 v[64:67], v112
    ds_read_b128 v[68:71], v116
    v_mfma_f32_32x32x16_bf16 v[144:159], v[16:19], v[24:27], v[144:159]
    ds_read_b128 v[72:75], v116 offset:4096
    ds_read_b128 v[76:79], v113
    v_mfma_f32_32x32x16_bf16 v[128:143], v[28:31], v[32:35], v[128:143]
    ds_read_b128 v[80:83], v117
    ds_read_b128 v[84:87], v117 offset:4096
    v_mfma_f32_32x32x16_bf16 v[144:159], v[28:31], v[36:39], v[144:159]
    ds_read_b128 v[88:91], v114
    ds_read_b128 v[92:95], v118
    v_mfma_f32_32x32x16_bf16 v[128:143], v[40:43], v[44:47], v[128:143]
    ds_read_b128 v[96:99], v118 offset:4096
    ds_read_b128 v[100:103], v115
    v_mfma_f32_32x32x16_bf16 v[144:159], v[40:43], v[48:51], v[144:159]
    ds_read_b128 v[104:107], v119
    ds_read_b128 v[108:111], v119 offset:4096
    v_mfma_f32_32x32x16_bf16 v[128:143], v[52:55], v[56:59], v[128:143]
    v_mfma_f32_32x32x16_bf16 v[144:159], v[52:55], v[60:63], v[144:159]
    v_add_u32 v112, 65536, v11
    v_add_u32 v116, 131072, v5
    v_xor_b32 v113, 32, v112
    v_xor_b32 v117, 32, v116
    v_xor_b32 v114, 64, v112
    v_xor_b32 v118, 64, v116
    v_xor_b32 v115, 96, v112
    v_xor_b32 v119, 96, v116
    s_waitcnt lgkmcnt(0)
    s_barrier
    v_mfma_f32_32x32x16_bf16 v[128:143], v[64:67], v[68:71], v[128:143]
    ds_read_b128 v[16:19], v112
    ds_read_b128 v[20:23], v116
    v_mfma_f32_32x32x16_bf16 v[144:159], v[64:67], v[72:75], v[144:159]
    ds_read_b128 v[24:27], v116 offset:4096
    ds_read_b128 v[28:31], v113
    v_mfma_f32_32x32x16_bf16 v[128:143], v[76:79], v[80:83], v[128:143]
    ds_read_b128 v[32:35], v117
    ds_read_b128 v[36:39], v117 offset:4096
    v_mfma_f32_32x32x16_bf16 v[144:159], v[76:79], v[84:87], v[144:159]
    ds_read_b128 v[40:43], v114
    ds_read_b128 v[44:47], v118
    v_mfma_f32_32x32x16_bf16 v[128:143], v[88:91], v[92:95], v[128:143]
    ds_read_b128 v[48:51], v118 offset:4096
    ds_read_b128 v[52:55], v115
    v_mfma_f32_32x32x16_bf16 v[144:159], v[88:91], v[96:99], v[144:159]
    ds_read_b128 v[56:59], v119
    ds_read_b128 v[60:63], v119 offset:4096
    v_mfma_f32_32x32x16_bf16 v[128:143], v[100:103], v[104:107], v[128:143]
    v_mfma_f32_32x32x16_bf16 v[144:159], v[100:103], v[108:111], v[144:159]
    s_waitcnt vmcnt(0)
    v_lshlrev_b32 v184, 16, v184
    v_lshlrev_b32 v185, 16, v185
    v_lshlrev_b32 v186, 16, v186
    v_mul_f32 v186, 1069066811, v186
    v_exp_f32 v186, v186
    s_nop 0
    v_cvt_pk_bf16_f32 v186, v186, v186
    v_and_b32 v186, 0xffff0000, v186
    v_mul_f32 v226, v186, v184
    v_mul_f32 v227, v186, v185
    v_mul_f32 v226, 1069066811, v226
    v_mul_f32 v227, 0.15915494, v227
    v_mul_f32 v188, 1.0, v226
    v_mul_f32 v189, 1.0, v227
    v_exp_f32 v188, v188
    v_rndne_f32 v190, v189
    v_sub_f32 v189, v189, v190
    v_cos_f32 v160, v189
    v_sin_f32 v161, v189
    v_mul_f32 v160, v160, v188
    v_mul_f32 v161, v161, v188
    v_xor_b32 v162, 0x80000000, v161
    v_add_u32 v112, 81920, v11
    v_add_u32 v116, 139264, v5
    v_xor_b32 v113, 32, v112
    v_xor_b32 v117, 32, v116
    v_xor_b32 v114, 64, v112
    v_xor_b32 v118, 64, v116
    v_xor_b32 v115, 96, v112
    v_xor_b32 v119, 96, v116
    s_waitcnt lgkmcnt(0)
    s_barrier
    v_mfma_f32_32x32x16_bf16 v[128:143], v[16:19], v[20:23], v[128:143]
    ds_read_b128 v[64:67], v112
    ds_read_b128 v[68:71], v116
    v_mfma_f32_32x32x16_bf16 v[144:159], v[16:19], v[24:27], v[144:159]
    ds_read_b128 v[72:75], v116 offset:4096
    ds_read_b128 v[76:79], v113
    v_mfma_f32_32x32x16_bf16 v[128:143], v[28:31], v[32:35], v[128:143]
    ds_read_b128 v[80:83], v117
    ds_read_b128 v[84:87], v117 offset:4096
    v_mfma_f32_32x32x16_bf16 v[144:159], v[28:31], v[36:39], v[144:159]
    ds_read_b128 v[88:91], v114
    ds_read_b128 v[92:95], v118
    v_mfma_f32_32x32x16_bf16 v[128:143], v[40:43], v[44:47], v[128:143]
    ds_read_b128 v[96:99], v118 offset:4096
    ds_read_b128 v[100:103], v115
    v_mfma_f32_32x32x16_bf16 v[144:159], v[40:43], v[48:51], v[144:159]
    ds_read_b128 v[104:107], v119
    ds_read_b128 v[108:111], v119 offset:4096
    v_mfma_f32_32x32x16_bf16 v[128:143], v[52:55], v[56:59], v[128:143]
    v_mfma_f32_32x32x16_bf16 v[144:159], v[52:55], v[60:63], v[144:159]
    v_add_f32 v188, -1.0, v160
    v_mul_f32 v189, v184, v184
    v_fmac_f32 v189, v185, v185
    v_rcp_f32 v189, v189
    v_mul_f32 v164, v188, v184
    v_fmac_f32 v164, v161, v185
    v_mul_f32 v165, v161, v184
    v_fma_f32 v165, -v188, v185, v165
    v_add_f32 v189, v189, v189
    v_mul_f32 v165, v165, v189
    v_mul_f32 v164, v164, v189
    v_xor_b32 v163, 0x80000000, v165
    v_mov_b32 v228, v164
    v_mov_b32 v229, v164
    v_mov_b32 v230, v165
    v_mov_b32 v231, v165
    buffer_load_dwordx2 v[120:121], v13, s[68:71], s14 offen offset:0 sc1
    buffer_load_dwordx2 v[124:125], v13, s[68:71], s14 offen offset:3584 sc1
    buffer_load_dwordx4 v[216:219], v244, s[68:71], s93 offen sc1
    v_add_u32 v112, 98304, v11
    v_add_u32 v116, 147456, v5
    v_xor_b32 v113, 32, v112
    v_xor_b32 v117, 32, v116
    v_xor_b32 v114, 64, v112
    v_xor_b32 v118, 64, v116
    v_xor_b32 v115, 96, v112
    v_xor_b32 v119, 96, v116
    s_waitcnt lgkmcnt(0)
    s_barrier
    v_mfma_f32_32x32x16_bf16 v[128:143], v[64:67], v[68:71], v[128:143]
    ds_read_b128 v[16:19], v112
    ds_read_b128 v[20:23], v116
    v_mfma_f32_32x32x16_bf16 v[144:159], v[64:67], v[72:75], v[144:159]
    ds_read_b128 v[24:27], v116 offset:4096
    ds_read_b128 v[28:31], v113
    v_mfma_f32_32x32x16_bf16 v[128:143], v[76:79], v[80:83], v[128:143]
    ds_read_b128 v[32:35], v117
    ds_read_b128 v[36:39], v117 offset:4096
    v_mfma_f32_32x32x16_bf16 v[144:159], v[76:79], v[84:87], v[144:159]
    ds_read_b128 v[40:43], v114
    ds_read_b128 v[44:47], v118
    v_mfma_f32_32x32x16_bf16 v[128:143], v[88:91], v[92:95], v[128:143]
    ds_read_b128 v[48:51], v118 offset:4096
    ds_read_b128 v[52:55], v115
    v_mfma_f32_32x32x16_bf16 v[144:159], v[88:91], v[96:99], v[144:159]
    ds_read_b128 v[56:59], v119
    ds_read_b128 v[60:63], v119 offset:4096
    v_mfma_f32_32x32x16_bf16 v[128:143], v[100:103], v[104:107], v[128:143]
    v_mfma_f32_32x32x16_bf16 v[144:159], v[100:103], v[108:111], v[144:159]
    v_mul_f32 v188, 0x41800000, v226
    v_mul_f32 v189, 0x41800000, v227
    v_exp_f32 v188, v188
    v_rndne_f32 v190, v189
    v_sub_f32 v189, v189, v190
    v_cos_f32 v166, v189
    v_sin_f32 v167, v189
    v_mul_f32 v166, v166, v188
    v_mul_f32 v167, v167, v188
    s_waitcnt lgkmcnt(0)
    s_barrier
    v_and_b32 v11, 3, v1
    v_mul_u32_u24 v11, 260, v11
    v_add_u32 v11, 157696, v11
    v_mfma_f32_32x32x16_bf16 v[128:143], v[16:19], v[20:23], v[128:143]
    v_mfma_f32_32x32x16_bf16 v[144:159], v[16:19], v[24:27], v[144:159]
    s_waitcnt vmcnt(0)
    v_xor_b32 v186, s11, v121
    v_xor_b32 v187, s11, v125
    v_or_b32 v186, v186, v187
    v_xor_b32 v187, s11, v217
    v_or_b32 v186, v186, v187
    v_xor_b32 v187, s11, v219
    v_or_b32 v186, v186, v187
    v_cmp_ne_u32 vcc, 0, v186
    s_cbranch_vccnz L_scs_slow
L_scs_ok:
    v_mfma_f32_32x32x16_bf16 v[128:143], v[28:31], v[32:35], v[128:143]
    v_cmp_gt_u32 vcc, 32, v1
    v_mov_b32 v121, 0
    v_mov_b32 v125, 0
    v_cndmask_b32 v208, 0, v216, vcc
    v_mfma_f32_32x32x16_bf16 v[144:159], v[28:31], v[36:39], v[144:159]
    v_cndmask_b32 v218, 0, v218, vcc
    v_cvt_pk_bf16_f32 v184, v218, v218
    v_and_b32 v184, 0xffff0000, v184
    v_sub_f32 v218, v218, v184
    v_mfma_f32_32x32x16_bf16 v[128:143], v[40:43], v[44:47], v[128:143]
    v_cvt_pk_bf16_f32 v216, v218, v184
    v_lshlrev_b32 v184, 16, v216
    v_sub_f32 v218, v218, v184
    v_mov_b32 v219, 0
    v_mfma_f32_32x32x16_bf16 v[144:159], v[40:43], v[48:51], v[144:159]
    v_cvt_pk_bf16_f32 v217, v218, v219
    v_mov_b32 v218, 0
    s_nop 1
    v_mfma_f32_32x32x16_bf16 v[192:207], v[216:219], v[220:223], 0
    v_mfma_f32_32x32x16_bf16 v[128:143], v[52:55], v[56:59], v[128:143]
    v_mfma_f32_32x32x16_bf16 v[144:159], v[52:55], v[60:63], v[144:159]
    v_mfma_f32_32x32x16_bf16 v[128:143], v[208:211], v[120:123], v[128:143]
    v_mfma_f32_32x32x16_bf16 v[144:159], v[208:211], v[124:127], v[144:159]
    s_nop 10
    v_pk_mul_f32 v[128:129], v[128:129], v[192:193]
    v_pk_mul_f32 v[130:131], v[130:131], v[194:195]
    v_pk_mul_f32 v[132:133], v[132:133], v[196:197]
    v_pk_mul_f32 v[134:135], v[134:135], v[198:199]
    v_pk_mul_f32 v[136:137], v[136:137], v[200:201]
    v_pk_mul_f32 v[138:139], v[138:139], v[202:203]
    v_pk_mul_f32 v[140:141], v[140:141], v[204:205]
    v_pk_mul_f32 v[142:143], v[142:143], v[206:207]
    v_pk_mul_f32 v[144:145], v[144:145], v[192:193]
    v_pk_mul_f32 v[146:147], v[146:147], v[194:195]
    v_pk_mul_f32 v[148:149], v[148:149], v[196:197]
    v_pk_mul_f32 v[150:151], v[150:151], v[198:199]
    v_pk_mul_f32 v[152:153], v[152:153], v[200:201]
    v_pk_mul_f32 v[154:155], v[154:155], v[202:203]
    v_pk_mul_f32 v[156:157], v[156:157], v[204:205]
    v_pk_mul_f32 v[158:159], v[158:159], v[206:207]
    v_pk_mul_f32 v[184:185], v[144:145], v[230:231]
    v_pk_mul_f32 v[186:187], v[128:129], v[230:231]
    v_pk_fma_f32 v[128:129], v[128:129], v[228:229], v[184:185] neg_lo:[0,0,1] neg_hi:[0,0,1]
    v_pk_fma_f32 v[144:145], v[144:145], v[228:229], v[186:187]
    v_pk_mul_f32 v[188:189], v[146:147], v[230:231]
    v_pk_mul_f32 v[190:191], v[130:131], v[230:231]
    v_pk_fma_f32 v[130:131], v[130:131], v[228:229], v[188:189] neg_lo:[0,0,1] neg_hi:[0,0,1]
    v_pk_fma_f32 v[146:147], v[146:147], v[228:229], v[190:191]
    v_pk_mul_f32 v[184:185], v[148:149], v[230:231]
    v_pk_mul_f32 v[186:187], v[132:133], v[230:231]
    v_pk_fma_f32 v[132:133], v[132:133], v[228:229], v[184:185] neg_lo:[0,0,1] neg_hi:[0,0,1]
    v_pk_fma_f32 v[148:149], v[148:149], v[228:229], v[186:187]
    v_pk_mul_f32 v[188:189], v[150:151], v[230:231]
    v_pk_mul_f32 v[190:191], v[134:135], v[230:231]
    v_pk_fma_f32 v[134:135], v[134:135], v[228:229], v[188:189] neg_lo:[0,0,1] neg_hi:[0,0,1]
    v_pk_fma_f32 v[150:151], v[150:151], v[228:229], v[190:191]
    v_pk_mul_f32 v[184:185], v[152:153], v[230:231]
    v_pk_mul_f32 v[186:187], v[136:137], v[230:231]
    v_pk_fma_f32 v[136:137], v[136:137], v[228:229], v[184:185] neg_lo:[0,0,1] neg_hi:[0,0,1]
    v_pk_fma_f32 v[152:153], v[152:153], v[228:229], v[186:187]
    v_pk_mul_f32 v[188:189], v[154:155], v[230:231]
    v_pk_mul_f32 v[190:191], v[138:139], v[230:231]
    v_pk_fma_f32 v[138:139], v[138:139], v[228:229], v[188:189] neg_lo:[0,0,1] neg_hi:[0,0,1]
    v_pk_fma_f32 v[154:155], v[154:155], v[228:229], v[190:191]
    v_pk_mul_f32 v[184:185], v[156:157], v[230:231]
    v_pk_mul_f32 v[186:187], v[140:141], v[230:231]
    v_pk_fma_f32 v[140:141], v[140:141], v[228:229], v[184:185] neg_lo:[0,0,1] neg_hi:[0,0,1]
    v_pk_fma_f32 v[156:157], v[156:157], v[228:229], v[186:187]
    v_pk_mul_f32 v[188:189], v[158:159], v[230:231]
    v_pk_mul_f32 v[190:191], v[142:143], v[230:231]
    v_pk_fma_f32 v[142:143], v[142:143], v[228:229], v[188:189] neg_lo:[0,0,1] neg_hi:[0,0,1]
    v_pk_fma_f32 v[158:159], v[158:159], v[228:229], v[190:191]
    s_setprio 0
    v_fma_f32 v188, v160, v128, v129
    v_fma_f32 v189, v160, v144, v145
    v_fmac_f32 v188, v162, v144
    v_fmac_f32 v189, v161, v128
    v_fma_f32 v190, v160, v188, v130
    v_fma_f32 v191, v160, v189, v146
    v_fmac_f32 v190, v162, v189
    v_fmac_f32 v191, v161, v188
    v_fma_f32 v188, v160, v190, v131
    v_fma_f32 v189, v160, v191, v147
    v_fmac_f32 v188, v162, v191
    v_fmac_f32 v189, v161, v190
    v_fma_f32 v190, v160, v188, v132
    v_fma_f32 v191, v160, v189, v148
    v_fmac_f32 v190, v162, v189
    v_fmac_f32 v191, v161, v188
    v_fma_f32 v188, v160, v190, v133
    v_fma_f32 v189, v160, v191, v149
    v_fmac_f32 v188, v162, v191
    v_fmac_f32 v189, v161, v190
    v_fma_f32 v190, v160, v188, v134
    v_fma_f32 v191, v160, v189, v150
    v_fmac_f32 v190, v162, v189
    v_fmac_f32 v191, v161, v188
    v_fma_f32 v188, v160, v190, v135
    v_fma_f32 v189, v160, v191, v151
    v_fmac_f32 v188, v162, v191
    v_fmac_f32 v189, v161, v190
    s_waitcnt lgkmcnt(0)
    s_barrier
    s_add_u32 m0, s97, 131072
    s_mov_b32 s88, 0
    buffer_load_dwordx4 v6, s[60:63], s88 offen  lds
    v_fma_f32 v190, v160, v188, v136
    v_fma_f32 v191, v160, v189, v152
    v_fmac_f32 v190, v162, v189
    v_fmac_f32 v191, v161, v188
    v_fma_f32 v188, v160, v190, v137
    v_fma_f32 v189, v160, v191, v153
    s_addk_i32 s88, 6144
    buffer_load_dwordx4 v7, s[60:63], s88 offen offset:1024  lds
    v_fmac_f32 v188, v162, v191
    v_fmac_f32 v189, v161, v190
    v_fma_f32 v190, v160, v188, v138
    v_fma_f32 v191, v160, v189, v154
    v_fmac_f32 v190, v162, v189
    v_fmac_f32 v191, v161, v188
    s_addk_i32 s88, 6144
    buffer_load_dwordx4 v6, s[60:63], s88 offen offset:2048  lds
    v_fma_f32 v188, v160, v190, v139
    v_fma_f32 v189, v160, v191, v155
    v_fmac_f32 v188, v162, v191
    v_fmac_f32 v189, v161, v190
    v_fma_f32 v190, v160, v188, v140
    v_fma_f32 v191, v160, v189, v156
    s_addk_i32 s88, 6144
    buffer_load_dwordx4 v7, s[60:63], s88 offen offset:3072  lds
    v_fmac_f32 v190, v162, v189
    v_fmac_f32 v191, v161, v188
    v_fma_f32 v188, v160, v190, v141
    v_fma_f32 v189, v160, v191, v157
    v_fmac_f32 v188, v162, v191
    v_fmac_f32 v189, v161, v190
    s_add_u32 m0, s97, 98304
    s_mov_b32 s88, 128
    buffer_load_dwordx4 v6, s[60:63], s88 offen  lds
    v_fma_f32 v190, v160, v188, v142
    v_fma_f32 v191, v160, v189, v158
    v_fmac_f32 v190, v162, v189
    v_fmac_f32 v191, v161, v188
    v_fma_f32 v188, v160, v190, v143
    v_fma_f32 v189, v160, v191, v159
    s_addk_i32 s88, 6144
    buffer_load_dwordx4 v7, s[60:63], s88 offen offset:1024  lds
    v_fmac_f32 v188, v162, v191
    v_fmac_f32 v189, v161, v190
    ds_write_b64 v214, v[188:189] offset:1792
    s_waitcnt lgkmcnt(0)
    s_barrier
    s_addk_i32 s88, 6144
    buffer_load_dwordx4 v6, s[60:63], s88 offen offset:2048  lds
    ds_read_b64 v[192:193], v214 offset:0
    ds_read_b64 v[194:195], v214 offset:256
    ds_read_b64 v[196:197], v214 offset:512
    ds_read_b64 v[198:199], v214 offset:768
    ds_read_b64 v[200:201], v214 offset:1024
    ds_read_b64 v[202:203], v214 offset:1280
    ds_read_b64 v[204:205], v214 offset:1536
    s_addk_i32 s88, 6144
    buffer_load_dwordx4 v7, s[60:63], s88 offen offset:3072  lds
    v_xor_b32 v190, 0x80000000, v167
    v_mov_b32 v185, s11
    v_mov_b32 v187, s11
    s_waitcnt lgkmcnt(5)
    v_fmac_f32 v194, v166, v192
    s_add_u32 m0, s97, 0
    s_mov_b32 s88, 256
    buffer_load_dwordx4 v6, s[60:63], s88 offen  lds
    v_fmac_f32 v195, v166, v193
    v_fmac_f32 v194, v190, v193
    v_fmac_f32 v195, v167, v192
    s_waitcnt lgkmcnt(4)
    v_fmac_f32 v196, v166, v194
    s_addk_i32 s88, 6144
    buffer_load_dwordx4 v7, s[60:63], s88 offen offset:1024  lds
    v_fmac_f32 v197, v166, v195
    v_fmac_f32 v196, v190, v195
    v_fmac_f32 v197, v167, v194
    s_waitcnt lgkmcnt(3)
    v_fmac_f32 v198, v166, v196
    s_addk_i32 s88, 6144
    buffer_load_dwordx4 v6, s[60:63], s88 offen offset:2048  lds
    v_fmac_f32 v199, v166, v197
    v_fmac_f32 v198, v190, v197
    v_fmac_f32 v199, v167, v196
    s_waitcnt lgkmcnt(2)
    v_fmac_f32 v200, v166, v198
    s_addk_i32 s88, 6144
    buffer_load_dwordx4 v7, s[60:63], s88 offen offset:3072  lds
    v_fmac_f32 v201, v166, v199
    v_fmac_f32 v200, v190, v199
    v_fmac_f32 v201, v167, v198
    s_waitcnt lgkmcnt(1)
    v_fmac_f32 v202, v166, v200
    v_fmac_f32 v203, v166, v201
    v_fmac_f32 v202, v190, v201
    v_fmac_f32 v203, v167, v200
    s_waitcnt lgkmcnt(0)
    v_fma_f32 v174, v166, v202, v204
    v_fma_f32 v175, v166, v203, v205
    v_fmac_f32 v174, v190, v203
    v_fmac_f32 v175, v167, v202
    v_fma_f32 v184, v166, v174, v188
    v_fma_f32 v186, v166, v175, v189
    v_fmac_f32 v184, v190, v175
    v_fmac_f32 v186, v167, v174
    buffer_store_dwordx4 v[184:187], v14, s[52:55], 0 offen sc1
    s_waitcnt vmcnt(9)
    s_waitcnt lgkmcnt(0)
    s_barrier
    s_add_u32 m0, s97, 16384
    s_mul_i32 s88, s80, 229376
    s_add_u32 s88, s88, 128
    buffer_load_dwordx4 v10, s[56:59], s88 offen  lds
    buffer_load_dwordx2 v[240:241], v242, s[68:71], s92 offen offset:0 sc1
    v_mul_f32 v188, 0x43000000, v226
    v_mul_f32 v189, 0x43000000, v227
    v_exp_f32 v188, v188
    s_addk_i32 s88, 27648
    buffer_load_dwordx4 v10, s[56:59], s88 offen offset:1024  lds
    v_rndne_f32 v190, v189
    v_sub_f32 v189, v189, v190
    v_cos_f32 v170, v189
    v_sin_f32 v171, v189
    v_mul_f32 v170, v170, v188
    v_mul_f32 v171, v171, v188
    s_addk_i32 s88, 27648
    buffer_load_dwordx4 v10, s[56:59], s88 offen offset:2048  lds
    v_mul_f32 v188, v247, v226
    v_mul_f32 v189, v247, v227
    v_exp_f32 v188, v188
    v_rndne_f32 v190, v189
    v_sub_f32 v189, v189, v190
    v_cos_f32 v172, v189
    s_addk_i32 s88, 27648
    buffer_load_dwordx4 v10, s[56:59], s88 offen offset:3072  lds
    v_sin_f32 v173, v189
    v_mul_f32 v172, v172, v188
    v_mul_f32 v173, v173, v188
    v_mul_f32 v188, v253, v226
    v_mul_f32 v189, v253, v227
    v_exp_f32 v188, v188
    v_rndne_f32 v190, v189
    v_sub_f32 v189, v189, v190
    v_cos_f32 v168, v189
    v_sin_f32 v169, v189
    v_mul_f32 v168, v168, v188
    v_mul_f32 v169, v169, v188
    v_xor_b32 v254, 0x80000000, v173
    v_add_u32 v3, 131072, v4
    ds_read_b128 v[16:19], v3 offset:0
    ds_read_b128 v[20:23], v3 offset:4096
    ds_read_b128 v[24:27], v3 offset:8192
    ds_read_b128 v[28:31], v3 offset:12288
    s_waitcnt vmcnt(10)
    s_waitcnt lgkmcnt(0)
    s_barrier
    s_add_u32 m0, s97, 131072
    s_mov_b32 s88, 384
    buffer_load_dwordx4 v6, s[60:63], s88 offen  lds
    v_add_u32 v3, 98304, v4
    ds_read_b128 v[32:35], v3 offset:0
    ds_read_b128 v[36:39], v3 offset:4096
    ds_read_b128 v[40:43], v3 offset:8192
    ds_read_b128 v[44:47], v3 offset:12288
    s_addk_i32 s88, 6144
    buffer_load_dwordx4 v7, s[60:63], s88 offen offset:1024  lds
    s_addk_i32 s88, 6144
    buffer_load_dwordx4 v6, s[60:63], s88 offen offset:2048  lds
    s_addk_i32 s88, 6144
    buffer_load_dwordx4 v7, s[60:63], s88 offen offset:3072  lds
    s_add_u32 m0, s97, 32768
    s_mul_i32 s88, s81, 229376
    s_add_u32 s88, s88, 128
    buffer_load_dwordx4 v10, s[56:59], s88 offen  lds
    s_addk_i32 s88, 27648
    buffer_load_dwordx4 v10, s[56:59], s88 offen offset:1024  lds
    s_addk_i32 s88, 27648
    buffer_load_dwordx4 v10, s[56:59], s88 offen offset:2048  lds
    s_waitcnt vmcnt(13)
    s_waitcnt lgkmcnt(0)
    s_barrier
    buffer_load_dwordx4 v[192:195], v232, s[52:55], 0 offen sc1
    buffer_load_dwordx4 v[196:199], v233, s[52:55], 0 offen sc1
    v_add_u32 v3, 0, v4
    s_addk_i32 s88, 27648
    buffer_load_dwordx4 v10, s[56:59], s88 offen offset:3072  lds
    ds_read_b128 v[48:51], v3 offset:0
    ds_read_b128 v[52:55], v3 offset:4096
    ds_read_b128 v[56:59], v3 offset:8192
    ds_read_b128 v[60:63], v3 offset:12288
    s_waitcnt vmcnt(13)
    v_cmp_ne_u32 vcc, s11, v241
    s_cbranch_vccnz L_scw0_slow
L_scw0_ok:
    ds_write_b32 v243, v240 offset:0
    s_add_u32 m0, s97, 98304
    s_mov_b32 s88, 512
    buffer_load_dwordx4 v6, s[60:63], s88 offen  lds
    s_addk_i32 s88, 6144
    buffer_load_dwordx4 v7, s[60:63], s88 offen offset:1024  lds
    s_addk_i32 s88, 6144
    buffer_load_dwordx4 v6, s[60:63], s88 offen offset:2048  lds
    s_waitcnt lgkmcnt(0)
    s_barrier
    s_addk_i32 s88, 6144
    buffer_load_dwordx4 v7, s[60:63], s88 offen offset:3072  lds
    s_add_u32 m0, s97, 49152
    s_mul_i32 s88, s82, 229376
    s_add_u32 s88, s88, 128
    buffer_load_dwordx4 v10, s[56:59], s88 offen  lds
    s_addk_i32 s88, 27648
    buffer_load_dwordx4 v10, s[56:59], s88 offen offset:1024  lds
    s_addk_i32 s88, 27648
    buffer_load_dwordx4 v10, s[56:59], s88 offen offset:2048  lds
    s_addk_i32 s88, 27648
    buffer_load_dwordx4 v10, s[56:59], s88 offen offset:3072  lds
    s_add_u32 m0, s97, 0
    s_mov_b32 s88, 640
    buffer_load_dwordx4 v6, s[60:63], s88 offen  lds
    s_waitcnt vmcnt(10)
    v_add_u32 v188, v193, v195
    v_add3_u32 v188, v188, v197, v199
    v_cmp_ne_u32 vcc, v224, v188
    s_cbranch_vccnz L_ag_slow
L_ag_ok:
    v_fma_f32 v184, v170, v196, v192
    v_fma_f32 v185, v170, v198, v194
    v_fma_f32 v184, -v171, v198, v184
    s_addk_i32 s88, 6144
    buffer_load_dwordx4 v7, s[60:63], s88 offen offset:1024  lds
    v_fmac_f32 v185, v171, v196
    v_mul_f32 v186, v172, v184
    v_mul_f32 v187, v172, v185
    v_fmac_f32 v186, v254, v185
    v_fmac_f32 v187, v173, v184
    ds_write_b64 v214, v[186:187] offset:1792
    s_waitcnt lgkmcnt(0)
    s_barrier
    s_addk_i32 s88, 6144
    buffer_load_dwordx4 v6, s[60:63], s88 offen offset:2048  lds
    ds_read_b64 v[192:193], v215 offset:1792
    ds_read_b64 v[194:195], v215 offset:2048
    ds_read_b64 v[196:197], v215 offset:2304
    ds_read_b64 v[198:199], v215 offset:2560
    ds_read_b64 v[200:201], v215 offset:2816
    ds_read_b64 v[202:203], v215 offset:3072
    ds_read_b64 v[204:205], v215 offset:3328
    s_addk_i32 s88, 6144
    buffer_load_dwordx4 v7, s[60:63], s88 offen offset:3072  lds
    ds_read_b64 v[206:207], v215 offset:3584
    s_waitcnt lgkmcnt(0)
    v_add_f32 v192, v192, v200
    v_add_f32 v193, v193, v201
    v_add_f32 v194, v194, v202
    s_add_u32 m0, s97, 114688
    s_mul_i32 s88, s83, 229376
    s_add_u32 s88, s88, 128
    buffer_load_dwordx4 v10, s[56:59], s88 offen  lds
    v_add_f32 v195, v195, v203
    v_add_f32 v196, v196, v204
    v_add_f32 v197, v197, v205
    v_add_f32 v198, v198, v206
    v_add_f32 v199, v199, v207
    v_add_f32 v192, v192, v196
    s_addk_i32 s88, 27648
    buffer_load_dwordx4 v10, s[56:59], s88 offen offset:1024  lds
    v_add_f32 v193, v193, v197
    v_add_f32 v194, v194, v198
    v_add_f32 v195, v195, v199
    v_add_f32 v192, v192, v194
    v_add_f32 v193, v193, v195
    v_fma_f32 v186, v168, v192, v174
    s_addk_i32 s88, 27648
    buffer_load_dwordx4 v10, s[56:59], s88 offen offset:2048  lds
    v_fma_f32 v187, v168, v193, v175
    v_fma_f32 v186, -v169, v193, v186
    v_fmac_f32 v187, v169, v192
    v_fmac_f32 v128, v160, v186
    v_fmac_f32 v144, v160, v187
    v_fmac_f32 v128, v162, v187
    s_addk_i32 s88, 27648
    buffer_load_dwordx4 v10, s[56:59], s88 offen offset:3072  lds
    v_fmac_f32 v144, v161, v186
    v_fmac_f32 v129, v160, v128
    v_fmac_f32 v145, v160, v144
    v_fmac_f32 v129, v162, v144
    v_fmac_f32 v145, v161, v128
    v_cvt_pk_bf16_f32 v192, v128, v129
    s_add_u32 m0, s97, 65536
    s_mul_i32 s88, s84, 229376
    s_add_u32 s88, s88, 128
    buffer_load_dwordx4 v10, s[56:59], s88 offen  lds
    v_cvt_pk_bf16_f32 v200, -v144, -v145
    v_fmac_f32 v130, v160, v129
    v_fmac_f32 v146, v160, v145
    v_fmac_f32 v130, v162, v145
    v_fmac_f32 v146, v161, v129
    v_fmac_f32 v131, v160, v130
    s_addk_i32 s88, 27648
    buffer_load_dwordx4 v10, s[56:59], s88 offen offset:1024  lds
    v_fmac_f32 v147, v160, v146
    v_fmac_f32 v131, v162, v146
    v_fmac_f32 v147, v161, v130
    v_cvt_pk_bf16_f32 v193, v130, v131
    v_cvt_pk_bf16_f32 v201, -v146, -v147
    v_fmac_f32 v132, v160, v131
    s_addk_i32 s88, 27648
    buffer_load_dwordx4 v10, s[56:59], s88 offen offset:2048  lds
    v_fmac_f32 v148, v160, v147
    v_fmac_f32 v132, v162, v147
    v_fmac_f32 v148, v161, v131
    v_fmac_f32 v133, v160, v132
    v_fmac_f32 v149, v160, v148
    v_fmac_f32 v133, v162, v148
    s_addk_i32 s88, 27648
    buffer_load_dwordx4 v10, s[56:59], s88 offen offset:3072  lds
    v_fmac_f32 v149, v161, v132
    v_cvt_pk_bf16_f32 v194, v132, v133
    v_cvt_pk_bf16_f32 v202, -v148, -v149
    v_fmac_f32 v134, v160, v133
    v_fmac_f32 v150, v160, v149
    v_fmac_f32 v134, v162, v149
    v_fmac_f32 v150, v161, v133
    s_waitcnt vmcnt(20)
    s_waitcnt lgkmcnt(0)
    s_barrier
    v_fmac_f32 v135, v160, v134
    v_fmac_f32 v151, v160, v150
    v_fmac_f32 v135, v162, v150
    v_fmac_f32 v151, v161, v134
    v_cvt_pk_bf16_f32 v195, v134, v135
    v_cvt_pk_bf16_f32 v203, -v150, -v151
    v_fmac_f32 v136, v160, v135
    v_fmac_f32 v152, v160, v151
    v_fmac_f32 v136, v162, v151
    v_fmac_f32 v152, v161, v135
    v_fmac_f32 v137, v160, v136
    v_fmac_f32 v153, v160, v152
    v_fmac_f32 v137, v162, v152
    v_fmac_f32 v153, v161, v136
    v_cvt_pk_bf16_f32 v196, v136, v137
    v_cvt_pk_bf16_f32 v204, -v152, -v153
    v_fmac_f32 v138, v160, v137
    v_fmac_f32 v154, v160, v153
    v_fmac_f32 v138, v162, v153
    v_fmac_f32 v154, v161, v137
    v_fmac_f32 v139, v160, v138
    v_fmac_f32 v155, v160, v154
    v_fmac_f32 v139, v162, v154
    v_fmac_f32 v155, v161, v138
    v_cvt_pk_bf16_f32 v197, v138, v139
    v_cvt_pk_bf16_f32 v205, -v154, -v155
    v_fmac_f32 v140, v160, v139
    v_fmac_f32 v156, v160, v155
    v_fmac_f32 v140, v162, v155
    v_fmac_f32 v156, v161, v139
    v_fmac_f32 v141, v160, v140
    v_fmac_f32 v157, v160, v156
    v_fmac_f32 v141, v162, v156
    v_fmac_f32 v157, v161, v140
    v_cvt_pk_bf16_f32 v198, v140, v141
    v_cvt_pk_bf16_f32 v206, -v156, -v157
    v_fmac_f32 v142, v160, v141
    v_fmac_f32 v158, v160, v157
    v_fmac_f32 v142, v162, v157
    v_fmac_f32 v158, v161, v141
    v_fmac_f32 v143, v160, v142
    v_fmac_f32 v159, v160, v158
    v_fmac_f32 v143, v162, v158
    v_fmac_f32 v159, v161, v142
    v_cvt_pk_bf16_f32 v199, v142, v143
    v_cvt_pk_bf16_f32 v207, -v158, -v159
    s_setprio 3
    v_mfma_f32_32x32x16_bf16 v[128:143], v[192:195], v[176:179], 0
    v_mfma_f32_32x32x16_bf16 v[144:159], v[200:203], v[176:179], 0
    v_mfma_f32_32x32x16_bf16 v[128:143], v[196:199], v[180:183], v[128:143]
    v_mfma_f32_32x32x16_bf16 v[144:159], v[204:207], v[180:183], v[144:159]
    s_setprio 0
    s_add_u32 m0, s97, 81920
    s_mul_i32 s88, s85, 229376
    s_add_u32 s88, s88, 128
    buffer_load_dwordx4 v10, s[56:59], s88 offen  lds
    s_addk_i32 s88, 27648
    buffer_load_dwordx4 v10, s[56:59], s88 offen offset:1024  lds
    s_addk_i32 s88, 27648
    buffer_load_dwordx4 v10, s[56:59], s88 offen offset:2048  lds
    s_addk_i32 s88, 27648
    buffer_load_dwordx4 v10, s[56:59], s88 offen offset:3072  lds
    v_add_u32 v3, 131072, v4
    ds_read_b128 v[64:67], v3 offset:0
    ds_read_b128 v[68:71], v3 offset:4096
    ds_read_b128 v[72:75], v3 offset:8192
    ds_read_b128 v[76:79], v3 offset:12288
    s_waitcnt vmcnt(16)
    s_waitcnt lgkmcnt(0)
    s_barrier
    s_add_u32 m0, s97, 131072
    s_mov_b32 s88, 768
    buffer_load_dwordx4 v6, s[60:63], s88 offen  lds
    buffer_load_dwordx2 v[240:241], v242, s[68:71], s92 offen offset:512 sc1
    v_cvt_pk_bf16_f32 v208, v128, v129
    v_cvt_pk_bf16_f32 v209, v130, v131
    v_cvt_pk_bf16_f32 v210, v132, v133
    s_addk_i32 s88, 6144
    buffer_load_dwordx4 v7, s[60:63], s88 offen offset:1024  lds
    v_cvt_pk_bf16_f32 v211, v134, v135
    buffer_store_dwordx4 v[208:211], v12, s[68:71], s15 offen offset:0 sc1
    v_cvt_pk_bf16_f32 v212, v136, v137
    s_addk_i32 s88, 6144
    buffer_load_dwordx4 v6, s[60:63], s88 offen offset:2048  lds
    v_cvt_pk_bf16_f32 v213, v138, v139
    v_cvt_pk_bf16_f32 v214, v140, v141
    v_cvt_pk_bf16_f32 v215, v142, v143
    buffer_store_dwordx4 v[212:215], v12, s[68:71], s15 offen offset:2048 sc1
    v_cvt_pk_bf16_f32 v216, v144, v145
    s_addk_i32 s88, 6144
    buffer_load_dwordx4 v7, s[60:63], s88 offen offset:3072  lds
    v_cvt_pk_bf16_f32 v217, v146, v147
    v_cvt_pk_bf16_f32 v218, v148, v149
    v_add_u32 v3, 98304, v4
    ds_read_b128 v[80:83], v3 offset:0
    ds_read_b128 v[84:87], v3 offset:4096
    ds_read_b128 v[88:91], v3 offset:8192
    ds_read_b128 v[92:95], v3 offset:12288
    s_waitcnt vmcnt(15)
    s_waitcnt lgkmcnt(0)
    s_barrier
    s_add_u32 m0, s97, 16384
    s_mul_i32 s88, s86, 229376
    s_add_u32 s88, s88, 128
    buffer_load_dwordx4 v10, s[56:59], s88 offen  lds
    v_cvt_pk_bf16_f32 v219, v150, v151
    buffer_store_dwordx4 v[216:219], v12, s[68:71], s15 offen offset:1024 sc1
    v_cvt_pk_bf16_f32 v220, v152, v153
    s_addk_i32 s88, 27648
    buffer_load_dwordx4 v10, s[56:59], s88 offen offset:1024  lds
    v_cvt_pk_bf16_f32 v221, v154, v155
    v_cvt_pk_bf16_f32 v222, v156, v157
    v_cvt_pk_bf16_f32 v223, v158, v159
    buffer_store_dwordx4 v[220:223], v12, s[68:71], s15 offen offset:3072 sc1
    v_add_u32 v3, 0, v4
    s_addk_i32 s88, 27648
    buffer_load_dwordx4 v10, s[56:59], s88 offen offset:2048  lds
    ds_read_b128 v[96:99], v3 offset:0
    ds_read_b128 v[100:103], v3 offset:4096
    ds_read_b128 v[104:107], v3 offset:8192
    ds_read_b128 v[108:111], v3 offset:12288
    s_addk_i32 s88, 27648
    buffer_load_dwordx4 v10, s[56:59], s88 offen offset:3072  lds
    s_add_u32 m0, s97, 98304
    s_mov_b32 s88, 0
    buffer_load_dwordx4 v9, s[64:67], s88 offen  lds
    s_addk_i32 s88, 6144
    buffer_load_dwordx4 v9, s[64:67], s88 offen offset:1024  lds
    s_waitcnt vmcnt(19)
    s_waitcnt lgkmcnt(0)
    s_barrier
    s_addk_i32 s88, 6144
    buffer_load_dwordx4 v9, s[64:67], s88 offen offset:2048  lds
    s_waitcnt vmcnt(14)
    v_cmp_ne_u32 vcc, s11, v241
    s_cbranch_vccnz L_scw1_slow
L_scw1_ok:
    ds_write_b32 v243, v240 offset:256
    s_addk_i32 s88, 6144
    buffer_load_dwordx4 v9, s[64:67], s88 offen offset:3072  lds
    s_add_u32 m0, s97, 32768
    s_mov_b32 s88, 114688
    buffer_load_dwordx4 v9, s[64:67], s88 offen  lds
    s_addk_i32 s88, 6144
    buffer_load_dwordx4 v9, s[64:67], s88 offen offset:1024  lds
    s_addk_i32 s88, 6144
    buffer_load_dwordx4 v9, s[64:67], s88 offen offset:2048  lds
    s_addk_i32 s88, 6144
    buffer_load_dwordx4 v9, s[64:67], s88 offen offset:3072  lds
    s_add_u32 m0, s97, 0
    s_mov_b32 s88, 229376
    buffer_load_dwordx4 v9, s[64:67], s88 offen  lds
    s_waitcnt lgkmcnt(0)
    s_barrier
    s_addk_i32 s88, 6144
    buffer_load_dwordx4 v9, s[64:67], s88 offen offset:1024  lds
    s_addk_i32 s88, 6144
    buffer_load_dwordx4 v9, s[64:67], s88 offen offset:2048  lds
    s_addk_i32 s88, 6144
    buffer_load_dwordx4 v9, s[64:67], s88 offen offset:3072  lds
    s_add_u32 m0, s97, 49152
    s_mov_b32 s88, 344064
    buffer_load_dwordx4 v9, s[64:67], s88 offen  lds
    s_addk_i32 s88, 6144
    buffer_load_dwordx4 v9, s[64:67], s88 offen offset:1024  lds
    s_addk_i32 s88, 6144
    buffer_load_dwordx4 v9, s[64:67], s88 offen offset:2048  lds
    s_addk_i32 s88, 6144
    buffer_load_dwordx4 v9, s[64:67], s88 offen offset:3072  lds
    s_add_u32 m0, s97, 114688
    s_mov_b32 s88, 458752
    buffer_load_dwordx4 v9, s[64:67], s88 offen  lds
    s_waitcnt vmcnt(17)
    s_waitcnt lgkmcnt(0)
    s_barrier
    s_addk_i32 s88, 6144
    buffer_load_dwordx4 v9, s[64:67], s88 offen offset:1024  lds
    v_mov_b32 v2, s11
    s_mov_b64 exec, 1
    buffer_store_dword v2, off, s[68:71], s87 sc1
    s_mov_b64 exec, -1
    v_add_u32 v3, 131072, v4
    s_addk_i32 s88, 6144
    buffer_load_dwordx4 v9, s[64:67], s88 offen offset:2048  lds
    ds_read_b128 v[112:115], v3 offset:0
    ds_read_b128 v[116:119], v3 offset:4096
    ds_read_b128 v[120:123], v3 offset:8192
    ds_read_b128 v[124:127], v3 offset:12288
    s_addk_i32 s88, 6144
    buffer_load_dwordx4 v9, s[64:67], s88 offen offset:3072  lds
    s_add_u32 m0, s97, 65536
    s_mov_b32 s88, 573440
    buffer_load_dwordx4 v9, s[64:67], s88 offen  lds
    s_addk_i32 s88, 6144
    buffer_load_dwordx4 v9, s[64:67], s88 offen offset:1024  lds
    s_addk_i32 s88, 6144
    buffer_load_dwordx4 v9, s[64:67], s88 offen offset:2048  lds
    s_addk_i32 s88, 6144
    buffer_load_dwordx4 v9, s[64:67], s88 offen offset:3072  lds
    s_waitcnt lgkmcnt(0)
    s_barrier
    s_add_u32 m0, s97, 131072
    s_mov_b32 s88, 688128
    buffer_load_dwordx4 v9, s[64:67], s88 offen  lds
    s_addk_i32 s88, 6144
    buffer_load_dwordx4 v9, s[64:67], s88 offen offset:1024  lds
    s_addk_i32 s88, 6144
    buffer_load_dwordx4 v9, s[64:67], s88 offen offset:2048  lds
    s_addk_i32 s88, 6144
    buffer_load_dwordx4 v9, s[64:67], s88 offen offset:3072  lds
    s_add_u32 m0, s97, 81920
    s_mov_b32 s88, 57344
    buffer_load_dwordx4 v9, s[64:67], s88 offen  lds
    s_addk_i32 s88, 6144
    buffer_load_dwordx4 v9, s[64:67], s88 offen offset:1024  lds
    s_addk_i32 s88, 6144
    buffer_load_dwordx4 v9, s[64:67], s88 offen offset:2048  lds
    s_addk_i32 s88, 6144
    buffer_load_dwordx4 v9, s[64:67], s88 offen offset:3072  lds
    s_waitcnt vmcnt(12)
    s_waitcnt lgkmcnt(0)
    s_barrier
    s_setprio 1
    buffer_load_dword v14, v225, s[68:71], s90 offen sc1
    s_add_u32 m0, s97, 16384
    s_mov_b32 s88, 172032
    buffer_load_dwordx4 v9, s[64:67], s88 offen  lds
    s_addk_i32 s88, 6144
    buffer_load_dwordx4 v9, s[64:67], s88 offen offset:1024  lds
    s_addk_i32 s88, 6144
    buffer_load_dwordx4 v9, s[64:67], s88 offen offset:2048  lds
    s_addk_i32 s88, 6144
    buffer_load_dwordx4 v9, s[64:67], s88 offen offset:3072  lds
    s_setprio 1
    s_waitcnt vmcnt(4)
    v_cmp_ne_u32 vcc, s11, v14
    s_cbranch_vccnz L_slate
    s_add_u32 s92, s91, 0
    s_add_u32 s93, s92, 57344
    buffer_load_dwordx4 v[192:195], v12, s[68:71], s92 offen offset:0 sc1
    buffer_load_dwordx4 v[196:199], v12, s[68:71], s93 offen offset:0 sc1
    buffer_load_dwordx4 v[200:203], v12, s[68:71], s92 offen offset:1024 sc1
    buffer_load_dwordx4 v[204:207], v12, s[68:71], s93 offen offset:1024 sc1
    s_add_u32 s92, s91, 8192
    s_add_u32 s93, s92, 57344
    buffer_load_dwordx4 v[208:211], v12, s[68:71], s92 offen offset:0 sc1
    buffer_load_dwordx4 v[212:215], v12, s[68:71], s93 offen offset:0 sc1
    buffer_load_dwordx4 v[216:219], v12, s[68:71], s92 offen offset:1024 sc1
    buffer_load_dwordx4 v[220:223], v12, s[68:71], s93 offen offset:1024 sc1
    s_add_u32 s92, s91, 16384
    s_add_u32 s93, s92, 57344
    buffer_load_dwordx4 v[224:227], v12, s[68:71], s92 offen offset:0 sc1
    buffer_load_dwordx4 v[228:231], v12, s[68:71], s93 offen offset:0 sc1
    buffer_load_dwordx4 v[232:235], v12, s[68:71], s92 offen offset:1024 sc1
    buffer_load_dwordx4 v[236:239], v12, s[68:71], s93 offen offset:1024 sc1
    s_add_u32 s92, s91, 24576
    s_add_u32 s93, s92, 57344
    buffer_load_dwordx4 v[240:243], v12, s[68:71], s92 offen offset:0 sc1
    buffer_load_dwordx4 v[244:247], v12, s[68:71], s93 offen offset:0 sc1
    buffer_load_dwordx4 v[248:251], v12, s[68:71], s92 offen offset:1024 sc1
    buffer_load_dwordx4 v[252:255], v12, s[68:71], s93 offen offset:1024 sc1
    s_waitcnt vmcnt(16)
    v_mov_b32 v13, 1
    ds_write_b32 v8, v13
L_sjoin:
    ds_read_b32 v2, v11 offset:0
    s_waitcnt lgkmcnt(0)
    v_cmp_gt_u32 vcc, 1, v2
    s_cbranch_vccnz L_sp1_slow
L_sp1_ok:
    s_add_u32 m0, s97, 98304
    s_mov_b32 s88, 286720
    buffer_load_dwordx4 v9, s[64:67], s88 offen  lds
    s_addk_i32 s88, 6144
    buffer_load_dwordx4 v9, s[64:67], s88 offen offset:1024  lds
    s_addk_i32 s88, 6144
    buffer_load_dwordx4 v9, s[64:67], s88 offen offset:2048  lds
    s_addk_i32 s88, 6144
    buffer_load_dwordx4 v9, s[64:67], s88 offen offset:3072  lds
    s_waitcnt vmcnt(19)
    v_mfma_f32_32x32x16_bf16 v[128:143], v[16:19], v[192:195], 0
    s_add_u32 m0, s97, 32768
    s_mov_b32 s88, 401408
    buffer_load_dwordx4 v9, s[64:67], s88 offen  lds
    v_mfma_f32_32x32x16_bf16 v[144:159], v[20:23], v[192:195], 0
    s_addk_i32 s88, 6144
    buffer_load_dwordx4 v9, s[64:67], s88 offen offset:1024  lds
    s_waitcnt vmcnt(20)
    v_mfma_f32_32x32x16_bf16 v[160:175], v[16:19], v[196:199], 0
    s_addk_i32 s88, 6144
    buffer_load_dwordx4 v9, s[64:67], s88 offen offset:2048  lds
    v_mfma_f32_32x32x16_bf16 v[176:191], v[20:23], v[196:199], 0
    s_addk_i32 s88, 6144
    buffer_load_dwordx4 v9, s[64:67], s88 offen offset:3072  lds
    s_add_u32 s92, s91, 32768
    s_add_u32 s93, s92, 57344
    buffer_load_dwordx4 v[192:195], v12, s[68:71], s92 offen offset:0 sc1
    buffer_load_dwordx4 v[196:199], v12, s[68:71], s93 offen offset:0 sc1
    s_waitcnt vmcnt(23)
    v_mfma_f32_32x32x16_bf16 v[128:143], v[24:27], v[200:203], v[128:143]
    s_add_u32 m0, s97, 0
    s_mov_b32 s88, 516096
    buffer_load_dwordx4 v9, s[64:67], s88 offen  lds
    v_mfma_f32_32x32x16_bf16 v[144:159], v[28:31], v[200:203], v[144:159]
    s_addk_i32 s88, 6144
    buffer_load_dwordx4 v9, s[64:67], s88 offen offset:1024  lds
    s_waitcnt vmcnt(24)
    v_mfma_f32_32x32x16_bf16 v[160:175], v[24:27], v[204:207], v[160:175]
    s_addk_i32 s88, 6144
    buffer_load_dwordx4 v9, s[64:67], s88 offen offset:2048  lds
    v_mfma_f32_32x32x16_bf16 v[176:191], v[28:31], v[204:207], v[176:191]
    s_addk_i32 s88, 6144
    buffer_load_dwordx4 v9, s[64:67], s88 offen offset:3072  lds
    buffer_load_dwordx4 v[200:203], v12, s[68:71], s92 offen offset:1024 sc1
    buffer_load_dwordx4 v[204:207], v12, s[68:71], s93 offen offset:1024 sc1
    s_waitcnt vmcnt(27)
    v_mfma_f32_32x32x16_bf16 v[128:143], v[32:35], v[208:211], v[128:143]
    s_add_u32 m0, s97, 49152
    s_mov_b32 s88, 630784
    buffer_load_dwordx4 v9, s[64:67], s88 offen  lds
    v_mfma_f32_32x32x16_bf16 v[144:159], v[36:39], v[208:211], v[144:159]
    s_addk_i32 s88, 6144
    buffer_load_dwordx4 v9, s[64:67], s88 offen offset:1024  lds
    s_waitcnt vmcnt(28)
    v_mfma_f32_32x32x16_bf16 v[160:175], v[32:35], v[212:215], v[160:175]
    s_addk_i32 s88, 6144
    buffer_load_dwordx4 v9, s[64:67], s88 offen offset:2048  lds
    v_mfma_f32_32x32x16_bf16 v[176:191], v[36:39], v[212:215], v[176:191]
    s_addk_i32 s88, 6144
    buffer_load_dwordx4 v9, s[64:67], s88 offen offset:3072  lds
    s_add_u32 s92, s91, 40960
    s_add_u32 s93, s92, 57344
    buffer_load_dwordx4 v[208:211], v12, s[68:71], s92 offen offset:0 sc1
    buffer_load_dwordx4 v[212:215], v12, s[68:71], s93 offen offset:0 sc1
    v_lshrrev_b32 v36, 3, v0
    v_and_b32 v37, 7, v0
    v_lshlrev_b32 v37, 3, v37
    s_lshl_b32 s12, s8, 7
    s_movk_i32 s14, 896
    v_add_u32 v37, s12, v37
    global_load_dwordx2 v[20:21], v37, s[32:33]
    global_load_dwordx2 v[22:23], v37, s[32:33] offset:64
    v_mad_u32_u24 v37, v36, s14, v37
    s_mul_i32 s12, s7, 57344
    buffer_load_dwordx2 v[16:17], v37, s[76:79], s12 offen
    buffer_load_dwordx2 v[18:19], v37, s[76:79], s12 offen offset:64
    v_lshlrev_b32 v36, 4, v36
    s_lshl_b32 s12, s7, 10
    s_add_u32 s12, s12, 11796480
    buffer_load_dwordx4 v[24:27], v36, s[68:71], s12 offen sc1
    v_subrev_u32 v6, 256, v0
    v_lshrrev_b32 v36, 3, v6
    v_and_b32 v37, 7, v6
    v_lshlrev_b32 v37, 3, v37
    s_lshl_b32 s12, s8, 7
    s_movk_i32 s14, 896
    v_add_u32 v37, s12, v37
    v_mad_u32_u24 v37, v36, s14, v37
    s_mul_i32 s12, s7, 57344
    buffer_load_dwordx2 v[28:29], v37, s[76:79], s12 offen
    buffer_load_dwordx2 v[30:31], v37, s[76:79], s12 offen offset:64
    v_lshlrev_b32 v36, 4, v36
    s_lshl_b32 s12, s7, 10
    s_add_u32 s12, s12, 11796480
    buffer_load_dwordx4 v[32:35], v36, s[68:71], s12 offen sc1
    s_waitcnt vmcnt(39)
    v_mfma_f32_32x32x16_bf16 v[128:143], v[40:43], v[216:219], v[128:143]
    s_add_u32 m0, s97, 114688
    s_mov_b32 s88, 745472
    buffer_load_dwordx4 v9, s[64:67], s88 offen  lds
    v_mfma_f32_32x32x16_bf16 v[144:159], v[44:47], v[216:219], v[144:159]
    s_addk_i32 s88, 6144
    buffer_load_dwordx4 v9, s[64:67], s88 offen offset:1024  lds
    s_waitcnt vmcnt(40)
    v_mfma_f32_32x32x16_bf16 v[160:175], v[40:43], v[220:223], v[160:175]
    s_addk_i32 s88, 6144
    buffer_load_dwordx4 v9, s[64:67], s88 offen offset:2048  lds
    v_mfma_f32_32x32x16_bf16 v[176:191], v[44:47], v[220:223], v[176:191]
    s_addk_i32 s88, 6144
    buffer_load_dwordx4 v9, s[64:67], s88 offen offset:3072  lds
    buffer_load_dwordx4 v[216:219], v12, s[68:71], s92 offen offset:1024 sc1
    buffer_load_dwordx4 v[220:223], v12, s[68:71], s93 offen offset:1024 sc1
    s_setprio 0
    s_waitcnt vmcnt(43)
    v_mfma_f32_32x32x16_bf16 v[128:143], v[48:51], v[224:227], v[128:143]
    v_mfma_f32_32x32x16_bf16 v[144:159], v[52:55], v[224:227], v[144:159]
    s_waitcnt vmcnt(42)
    v_mfma_f32_32x32x16_bf16 v[160:175], v[48:51], v[228:231], v[160:175]
    v_mfma_f32_32x32x16_bf16 v[176:191], v[52:55], v[228:231], v[176:191]
    s_add_u32 s92, s91, 49152
    s_add_u32 s93, s92, 57344
    buffer_load_dwordx4 v[224:227], v12, s[68:71], s92 offen offset:0 sc1
    buffer_load_dwordx4 v[228:231], v12, s[68:71], s93 offen offset:0 sc1
    s_waitcnt vmcnt(43)
    v_mfma_f32_32x32x16_bf16 v[128:143], v[56:59], v[232:235], v[128:143]
    v_mfma_f32_32x32x16_bf16 v[144:159], v[60:63], v[232:235], v[144:159]
    s_waitcnt vmcnt(42)
    v_mfma_f32_32x32x16_bf16 v[160:175], v[56:59], v[236:239], v[160:175]
    v_mfma_f32_32x32x16_bf16 v[176:191], v[60:63], v[236:239], v[176:191]
    buffer_load_dwordx4 v[232:235], v12, s[68:71], s92 offen offset:1024 sc1
    buffer_load_dwordx4 v[236:239], v12, s[68:71], s93 offen offset:1024 sc1
    s_waitcnt vmcnt(43)
    v_mfma_f32_32x32x16_bf16 v[128:143], v[64:67], v[240:243], v[128:143]
    v_mfma_f32_32x32x16_bf16 v[144:159], v[68:71], v[240:243], v[144:159]
    s_waitcnt vmcnt(42)
    v_mfma_f32_32x32x16_bf16 v[160:175], v[64:67], v[244:247], v[160:175]
    v_mfma_f32_32x32x16_bf16 v[176:191], v[68:71], v[244:247], v[176:191]
    s_waitcnt vmcnt(41)
    v_mfma_f32_32x32x16_bf16 v[128:143], v[72:75], v[248:251], v[128:143]
    v_mfma_f32_32x32x16_bf16 v[144:159], v[76:79], v[248:251], v[144:159]
    s_waitcnt vmcnt(40)
    v_mfma_f32_32x32x16_bf16 v[160:175], v[72:75], v[252:255], v[160:175]
    v_mfma_f32_32x32x16_bf16 v[176:191], v[76:79], v[252:255], v[176:191]
    s_waitcnt vmcnt(31)
    v_mfma_f32_32x32x16_bf16 v[128:143], v[80:83], v[192:195], v[128:143]
    s_mov_b32 s12, 65536
    s_cmp_eq_u32 s4, 1
    s_cselect_b32 s12, 73728, s12
    s_cmp_eq_u32 s4, 2
    s_cselect_b32 s12, 131072, s12
    s_cmp_eq_u32 s4, 3
    s_cselect_b32 s12, 139264, s12
    v_mfma_f32_32x32x16_bf16 v[144:159], v[84:87], v[192:195], v[144:159]
    v_and_b32 v13, 7, v1
    v_lshrrev_b32 v12, 5, v1
    v_xor_b32 v13, v13, v12
    v_lshlrev_b32 v13, 4, v13
    v_and_b32 v12, 31, v1
    v_lshl_add_u32 v12, v12, 7, v13
    s_waitcnt vmcnt(30)
    v_mfma_f32_32x32x16_bf16 v[160:175], v[80:83], v[196:199], v[160:175]
    v_add_u32 v12, s12, v12
    v_lshlrev_b32 v7, 4, v6
    v_add_u32 v7, 147456, v7
    v_lshlrev_b32 v4, 2, v6
    v_add_u32 v4, 155648, v4
    s_waitcnt vmcnt(10)
    v_mfma_f32_32x32x16_bf16 v[176:191], v[84:87], v[196:199], v[176:191]
    ds_write_b128 v7, v[28:31] offset:12288
    v_lshlrev_b32 v56, 16, v28
    v_and_b32 v57, 0xffff0000, v28
    v_lshlrev_b32 v64, 16, v20
    v_and_b32 v65, 0xffff0000, v20
    v_mfma_f32_32x32x16_bf16 v[128:143], v[88:91], v[200:203], v[128:143]
    v_lshlrev_b32 v58, 16, v29
    v_and_b32 v59, 0xffff0000, v29
    v_lshlrev_b32 v66, 16, v21
    v_and_b32 v67, 0xffff0000, v21
    v_lshlrev_b32 v60, 16, v30
    v_and_b32 v61, 0xffff0000, v30
    v_mfma_f32_32x32x16_bf16 v[144:159], v[92:95], v[200:203], v[144:159]
    v_lshlrev_b32 v68, 16, v22
    v_and_b32 v69, 0xffff0000, v22
    v_lshlrev_b32 v62, 16, v31
    v_and_b32 v63, 0xffff0000, v31
    v_lshlrev_b32 v70, 16, v23
    v_and_b32 v71, 0xffff0000, v23
    v_mfma_f32_32x32x16_bf16 v[160:175], v[88:91], v[204:207], v[160:175]
    v_and_b32 v32, 0xffff0000, v32
    v_mov_b32 v33, v34
    v_mul_f32 v34, v33, v33
    v_mul_f32 v32, v32, v33
    v_mul_f32 v35, 0xbfb8aa3b, v34
    v_fma_f32 v28, v56, v33, v32
    v_mfma_f32_32x32x16_bf16 v[176:191], v[92:95], v[204:207], v[176:191]
    v_mul_f32 v64, v64, v28
    v_fma_f32 v29, v57, v33, v32
    v_mul_f32 v65, v65, v29
    v_fma_f32 v30, v58, v33, v32
    v_mul_f32 v66, v66, v30
    v_fma_f32 v31, v59, v33, v32
    v_mfma_f32_32x32x16_bf16 v[128:143], v[96:99], v[208:211], v[128:143]
    v_mul_f32 v67, v67, v31
    v_fma_f32 v28, v60, v33, v32
    v_mul_f32 v68, v68, v28
    v_fma_f32 v29, v61, v33, v32
    v_mul_f32 v69, v69, v29
    v_fma_f32 v30, v62, v33, v32
    v_mfma_f32_32x32x16_bf16 v[144:159], v[100:103], v[208:211], v[144:159]
    v_mul_f32 v70, v70, v30
    v_fma_f32 v31, v63, v33, v32
    v_mul_f32 v71, v71, v31
    ds_write_b32 v4, v35
    v_lshlrev_b32 v40, 16, v16
    v_mfma_f32_32x32x16_bf16 v[160:175], v[96:99], v[212:215], v[160:175]
    v_and_b32 v41, 0xffff0000, v16
    v_lshlrev_b32 v48, 16, v20
    v_and_b32 v49, 0xffff0000, v20
    v_lshlrev_b32 v42, 16, v17
    v_and_b32 v43, 0xffff0000, v17
    v_lshlrev_b32 v50, 16, v21
    v_mfma_f32_32x32x16_bf16 v[176:191], v[100:103], v[212:215], v[176:191]
    v_and_b32 v51, 0xffff0000, v21
    v_lshlrev_b32 v44, 16, v18
    v_and_b32 v45, 0xffff0000, v18
    v_lshlrev_b32 v52, 16, v22
    v_and_b32 v53, 0xffff0000, v22
    v_lshlrev_b32 v46, 16, v19
    s_waitcnt vmcnt(5)
    v_mfma_f32_32x32x16_bf16 v[128:143], v[104:107], v[216:219], v[128:143]
    v_and_b32 v47, 0xffff0000, v19
    v_lshlrev_b32 v54, 16, v23
    v_and_b32 v55, 0xffff0000, v23
    v_and_b32 v24, 0xffff0000, v24
    v_mov_b32 v25, v26
    v_mul_f32 v26, v25, v25
    v_mfma_f32_32x32x16_bf16 v[144:159], v[108:111], v[216:219], v[144:159]
    v_mul_f32 v24, v24, v25
    v_mul_f32 v27, 0xbfb8aa3b, v26
    v_fma_f32 v16, v40, v25, v24
    v_mul_f32 v48, v48, v16
    v_fma_f32 v17, v41, v25, v24
    v_mul_f32 v49, v49, v17
    s_waitcnt vmcnt(4)
    v_mfma_f32_32x32x16_bf16 v[160:175], v[104:107], v[220:223], v[160:175]
    v_fma_f32 v18, v42, v25, v24
    v_mul_f32 v50, v50, v18
    v_fma_f32 v19, v43, v25, v24
    v_mul_f32 v51, v51, v19
    v_fma_f32 v16, v44, v25, v24
    v_mul_f32 v52, v52, v16
    v_mfma_f32_32x32x16_bf16 v[176:191], v[108:111], v[220:223], v[176:191]
    v_fma_f32 v17, v45, v25, v24
    v_mul_f32 v53, v53, v17
    v_fma_f32 v18, v46, v25, v24
    v_mul_f32 v54, v54, v18
    v_fma_f32 v19, v47, v25, v24
    v_mul_f32 v55, v55, v19
    s_waitcnt vmcnt(3)
    v_mov_b32 v14, 2
    ds_write_b32 v8, v14
    v_mfma_f32_32x32x16_bf16 v[128:143], v[112:115], v[224:227], v[128:143]
    v_lshrrev_b32 v72, 3, v0
    v_and_b32 v37, 7, v0
    v_and_b32 v36, 7, v72
    v_xor_b32 v36, v36, v37
    v_lshlrev_b32 v36, 4, v36
    v_lshl_add_u32 v73, v72, 7, v36
    v_mfma_f32_32x32x16_bf16 v[144:159], v[116:119], v[224:227], v[144:159]
    v_and_b32 v74, 0x23, v72
    v_bfe_u32 v36, v72, 2, 2
    v_lshl_or_b32 v74, v36, 3, v74
    v_bfe_u32 v36, v72, 4, 1
    v_lshl_or_b32 v74, v36, 2, v74
    v_and_b32 v36, 2, v74
    s_waitcnt vmcnt(2)
    v_mfma_f32_32x32x16_bf16 v[160:175], v[112:115], v[228:231], v[160:175]
    v_lshlrev_b32 v36, 2, v36
    v_and_or_b32 v36, v74, 7, v36
    v_xor_b32 v36, v36, v37
    v_lshlrev_b32 v36, 4, v36
    v_lshl_add_u32 v74, v74, 8, v36
    v_lshlrev_b32 v37, 4, v37
    v_mfma_f32_32x32x16_bf16 v[176:191], v[116:119], v[228:231], v[176:191]
    s_movk_i32 s14, 1792
    v_mad_u32_u24 v72, v72, s14, v37
    s_mul_i32 s98, s7, 114688
    s_lshl_b32 s14, s8, 8
    s_add_u32 s98, s98, s14
    ds_read_b32 v2, v11 offset:0
    s_waitcnt vmcnt(1)
    v_mfma_f32_32x32x16_bf16 v[128:143], v[120:123], v[232:235], v[128:143]
    v_mfma_f32_32x32x16_bf16 v[144:159], v[124:127], v[232:235], v[144:159]
    s_waitcnt vmcnt(0)
    v_mfma_f32_32x32x16_bf16 v[160:175], v[120:123], v[236:239], v[160:175]
    v_mfma_f32_32x32x16_bf16 v[176:191], v[124:127], v[236:239], v[176:191]
    s_setprio 0
    s_waitcnt lgkmcnt(0)
    v_cmp_gt_u32 vcc, 2, v2
    s_cbranch_vccnz L_sp2_slow
L_sp2_ok:
    s_nop 3
    v_cvt_pk_bf16_f32 v192, v128, v129
    v_cvt_pk_bf16_f32 v193, v130, v131
    v_cvt_pk_bf16_f32 v194, v144, v145
    v_cvt_pk_bf16_f32 v195, v146, v147
    v_xor_b32 v13, 0, v12
    ds_write_b128 v13, v[192:195] offset:0
    v_cvt_pk_bf16_f32 v196, v132, v133
    v_cvt_pk_bf16_f32 v197, v134, v135
    v_cvt_pk_bf16_f32 v198, v148, v149
    v_cvt_pk_bf16_f32 v199, v150, v151
    v_xor_b32 v13, 32, v12
    ds_write_b128 v13, v[196:199] offset:0
    v_cvt_pk_bf16_f32 v200, v136, v137
    v_cvt_pk_bf16_f32 v201, v138, v139
    v_cvt_pk_bf16_f32 v202, v152, v153
    v_cvt_pk_bf16_f32 v203, v154, v155
    v_xor_b32 v13, 64, v12
    ds_write_b128 v13, v[200:203] offset:0
    v_cvt_pk_bf16_f32 v204, v140, v141
    v_cvt_pk_bf16_f32 v205, v142, v143
    v_cvt_pk_bf16_f32 v206, v156, v157
    v_cvt_pk_bf16_f32 v207, v158, v159
    v_xor_b32 v13, 96, v12
    ds_write_b128 v13, v[204:207] offset:0
    v_cvt_pk_bf16_f32 v208, v160, v161
    v_cvt_pk_bf16_f32 v209, v162, v163
    v_cvt_pk_bf16_f32 v210, v176, v177
    v_cvt_pk_bf16_f32 v211, v178, v179
    v_xor_b32 v13, 0, v12
    ds_write_b128 v13, v[208:211] offset:4096
    v_cvt_pk_bf16_f32 v212, v164, v165
    v_cvt_pk_bf16_f32 v213, v166, v167
    v_cvt_pk_bf16_f32 v214, v180, v181
    v_cvt_pk_bf16_f32 v215, v182, v183
    v_xor_b32 v13, 32, v12
    ds_write_b128 v13, v[212:215] offset:4096
    v_cvt_pk_bf16_f32 v216, v168, v169
    v_cvt_pk_bf16_f32 v217, v170, v171
    v_cvt_pk_bf16_f32 v218, v184, v185
    v_cvt_pk_bf16_f32 v219, v186, v187
    v_xor_b32 v13, 64, v12
    ds_write_b128 v13, v[216:219] offset:4096
    v_cvt_pk_bf16_f32 v220, v172, v173
    v_cvt_pk_bf16_f32 v221, v174, v175
    v_cvt_pk_bf16_f32 v222, v188, v189
    v_cvt_pk_bf16_f32 v223, v190, v191
    v_xor_b32 v13, 96, v12
    ds_write_b128 v13, v[220:223] offset:4096
    v_mov_b32 v14, 3
    ds_write_b32 v8, v14
    ds_read_b32 v2, v11 offset:1024
    s_waitcnt lgkmcnt(0)
    v_cmp_gt_u32 vcc, 3, v2
    s_cbranch_vccnz L_ssd_slow
L_ssd_ok:
    v_add_u32 v13, 61440, v73
    ds_read_b128 v[224:227], v13
    ds_read_b128 v[228:231], v13 offset:8192
    v_add_u32 v13, 126976, v73
    ds_read_b128 v[232:235], v13
    ds_read_b128 v[236:239], v13 offset:8192
    s_waitcnt lgkmcnt(3)
    v_lshlrev_b32 v13, 16, v224
    v_and_b32 v224, 0xffff0000, v224
    v_add_f32 v64, v64, v13
    v_add_f32 v65, v65, v224
    v_lshlrev_b32 v13, 16, v225
    v_and_b32 v225, 0xffff0000, v225
    v_add_f32 v66, v66, v13
    v_add_f32 v67, v67, v225
    v_lshlrev_b32 v13, 16, v226
    v_and_b32 v226, 0xffff0000, v226
    v_add_f32 v68, v68, v13
    v_add_f32 v69, v69, v226
    v_lshlrev_b32 v13, 16, v227
    v_and_b32 v227, 0xffff0000, v227
    v_add_f32 v70, v70, v13
    v_add_f32 v71, v71, v227
    s_waitcnt lgkmcnt(2)
    v_lshlrev_b32 v13, 16, v228
    v_and_b32 v228, 0xffff0000, v228
    v_add_f32 v64, v64, v13
    v_add_f32 v65, v65, v228
    v_lshlrev_b32 v13, 16, v229
    v_and_b32 v229, 0xffff0000, v229
    v_add_f32 v66, v66, v13
    v_add_f32 v67, v67, v229
    v_lshlrev_b32 v13, 16, v230
    v_and_b32 v230, 0xffff0000, v230
    v_add_f32 v68, v68, v13
    v_add_f32 v69, v69, v230
    v_lshlrev_b32 v13, 16, v231
    v_and_b32 v231, 0xffff0000, v231
    v_add_f32 v70, v70, v13
    v_add_f32 v71, v71, v231
    s_waitcnt lgkmcnt(1)
    v_lshlrev_b32 v13, 16, v232
    v_and_b32 v232, 0xffff0000, v232
    v_add_f32 v64, v64, v13
    v_add_f32 v65, v65, v232
    v_lshlrev_b32 v13, 16, v233
    v_and_b32 v233, 0xffff0000, v233
    v_add_f32 v66, v66, v13
    v_add_f32 v67, v67, v233
    v_lshlrev_b32 v13, 16, v234
    v_and_b32 v234, 0xffff0000, v234
    v_add_f32 v68, v68, v13
    v_add_f32 v69, v69, v234
    v_lshlrev_b32 v13, 16, v235
    v_and_b32 v235, 0xffff0000, v235
    v_add_f32 v70, v70, v13
    v_add_f32 v71, v71, v235
    s_waitcnt lgkmcnt(0)
    v_lshlrev_b32 v13, 16, v236
    v_and_b32 v236, 0xffff0000, v236
    v_add_f32 v64, v64, v13
    v_add_f32 v65, v65, v236
    v_lshlrev_b32 v13, 16, v237
    v_and_b32 v237, 0xffff0000, v237
    v_add_f32 v66, v66, v13
    v_add_f32 v67, v67, v237
    v_lshlrev_b32 v13, 16, v238
    v_and_b32 v238, 0xffff0000, v238
    v_add_f32 v68, v68, v13
    v_add_f32 v69, v69, v238
    v_lshlrev_b32 v13, 16, v239
    v_and_b32 v239, 0xffff0000, v239
    v_add_f32 v70, v70, v13
    v_add_f32 v71, v71, v239
    v_mul_f32 v64, v34, v64
    v_mul_f32 v65, v34, v65
    v_mul_f32 v66, v34, v66
    v_mul_f32 v67, v34, v67
    v_mul_f32 v68, v34, v68
    v_mul_f32 v69, v34, v69
    v_mul_f32 v70, v34, v70
    v_mul_f32 v71, v34, v71
    v_add_u32 v13, 65536, v73
    ds_read_b128 v[240:243], v13
    ds_read_b128 v[244:247], v13 offset:8192
    v_add_u32 v13, 131072, v73
    ds_read_b128 v[248:251], v13
    ds_read_b128 v[252:255], v13 offset:8192
    ds_write_b128 v7, v[64:67]
    ds_write_b128 v7, v[68:71] offset:4096
    s_waitcnt lgkmcnt(5)
    v_lshlrev_b32 v13, 16, v240
    v_and_b32 v240, 0xffff0000, v240
    v_add_f32 v48, v48, v13
    v_add_f32 v49, v49, v240
    v_lshlrev_b32 v13, 16, v241
    v_and_b32 v241, 0xffff0000, v241
    v_add_f32 v50, v50, v13
    v_add_f32 v51, v51, v241
    v_lshlrev_b32 v13, 16, v242
    v_and_b32 v242, 0xffff0000, v242
    v_add_f32 v52, v52, v13
    v_add_f32 v53, v53, v242
    v_lshlrev_b32 v13, 16, v243
    v_and_b32 v243, 0xffff0000, v243
    v_add_f32 v54, v54, v13
    v_add_f32 v55, v55, v243
    s_waitcnt lgkmcnt(4)
    v_lshlrev_b32 v13, 16, v244
    v_and_b32 v244, 0xffff0000, v244
    v_add_f32 v48, v48, v13
    v_add_f32 v49, v49, v244
    v_lshlrev_b32 v13, 16, v245
    v_and_b32 v245, 0xffff0000, v245
    v_add_f32 v50, v50, v13
    v_add_f32 v51, v51, v245
    v_lshlrev_b32 v13, 16, v246
    v_and_b32 v246, 0xffff0000, v246
    v_add_f32 v52, v52, v13
    v_add_f32 v53, v53, v246
    v_lshlrev_b32 v13, 16, v247
    v_and_b32 v247, 0xffff0000, v247
    v_add_f32 v54, v54, v13
    v_add_f32 v55, v55, v247
    s_waitcnt lgkmcnt(3)
    v_lshlrev_b32 v13, 16, v248
    v_and_b32 v248, 0xffff0000, v248
    v_add_f32 v48, v48, v13
    v_add_f32 v49, v49, v248
    v_lshlrev_b32 v13, 16, v249
    v_and_b32 v249, 0xffff0000, v249
    v_add_f32 v50, v50, v13
    v_add_f32 v51, v51, v249
    v_lshlrev_b32 v13, 16, v250
    v_and_b32 v250, 0xffff0000, v250
    v_add_f32 v52, v52, v13
    v_add_f32 v53, v53, v250
    v_lshlrev_b32 v13, 16, v251
    v_and_b32 v251, 0xffff0000, v251
    v_add_f32 v54, v54, v13
    v_add_f32 v55, v55, v251
    s_waitcnt lgkmcnt(2)
    v_lshlrev_b32 v13, 16, v252
    v_and_b32 v252, 0xffff0000, v252
    v_add_f32 v48, v48, v13
    v_add_f32 v49, v49, v252
    v_lshlrev_b32 v13, 16, v253
    v_and_b32 v253, 0xffff0000, v253
    v_add_f32 v50, v50, v13
    v_add_f32 v51, v51, v253
    v_lshlrev_b32 v13, 16, v254
    v_and_b32 v254, 0xffff0000, v254
    v_add_f32 v52, v52, v13
    v_add_f32 v53, v53, v254
    v_lshlrev_b32 v13, 16, v255
    v_and_b32 v255, 0xffff0000, v255
    v_add_f32 v54, v54, v13
    v_add_f32 v55, v55, v255
    v_mul_f32 v48, v26, v48
    v_mul_f32 v49, v26, v49
    v_mul_f32 v50, v26, v50
    v_mul_f32 v51, v26, v51
    v_mul_f32 v52, v26, v52
    v_mul_f32 v53, v26, v53
    v_mul_f32 v54, v26, v54
    v_mul_f32 v55, v26, v55
    v_add_u32 v73, 81920, v74
    v_add_u32 v74, 16384, v74
    v_xor_b32 v75, 128, v73
    v_xor_b32 v24, 128, v74
    s_waitcnt lgkmcnt(0)
    s_barrier
    ds_read_b128 v[96:99], v73
    ds_read_b128 v[104:107], v74
    ds_read_b128 v[100:103], v75
    ds_read_b128 v[108:111], v24
    s_waitcnt lgkmcnt(2)
    v_add_f32 v96, v96, v104
    v_add_f32 v97, v97, v105
    v_add_f32 v98, v98, v106
    v_add_f32 v99, v99, v107
    v_mul_f32 v104, v27, v96
    v_mul_f32 v105, v27, v97
    v_mul_f32 v106, v27, v98
    v_mul_f32 v107, v27, v99
    v_exp_f32 v104, v104
    v_exp_f32 v105, v105
    v_exp_f32 v106, v106
    v_exp_f32 v107, v107
    v_add_f32 v104, 1.0, v104
    v_add_f32 v105, 1.0, v105
    v_add_f32 v106, 1.0, v106
    v_add_f32 v107, 1.0, v107
    v_rcp_f32 v104, v104
    v_mul_f32 v96, v48, v96
    v_rcp_f32 v105, v105
    v_mul_f32 v97, v49, v97
    v_rcp_f32 v106, v106
    v_mul_f32 v98, v50, v98
    v_rcp_f32 v107, v107
    v_mul_f32 v99, v51, v99
    v_fmac_f32 v40, v96, v104
    v_fmac_f32 v41, v97, v105
    v_fmac_f32 v42, v98, v106
    v_fmac_f32 v43, v99, v107
    buffer_store_dwordx4 v[40:43], v72, s[72:75], s98 offen sc1
    s_waitcnt lgkmcnt(0)
    v_add_f32 v100, v100, v108
    v_add_f32 v101, v101, v109
    v_add_f32 v102, v102, v110
    v_add_f32 v103, v103, v111
    v_mul_f32 v108, v27, v100
    v_mul_f32 v109, v27, v101
    v_mul_f32 v110, v27, v102
    v_mul_f32 v111, v27, v103
    v_exp_f32 v108, v108
    v_exp_f32 v109, v109
    v_exp_f32 v110, v110
    v_exp_f32 v111, v111
    v_add_f32 v108, 1.0, v108
    v_add_f32 v109, 1.0, v109
    v_add_f32 v110, 1.0, v110
    v_add_f32 v111, 1.0, v111
    v_rcp_f32 v108, v108
    v_mul_f32 v100, v52, v100
    v_rcp_f32 v109, v109
    v_mul_f32 v101, v53, v101
    v_rcp_f32 v110, v110
    v_mul_f32 v102, v54, v102
    v_rcp_f32 v111, v111
    v_mul_f32 v103, v55, v103
    v_fmac_f32 v44, v100, v108
    v_fmac_f32 v45, v101, v109
    v_fmac_f32 v46, v102, v110
    v_fmac_f32 v47, v103, v111
    buffer_store_dwordx4 v[44:47], v72, s[72:75], s98 offen offset:128 sc1
    s_endpgm
L_grole:
    s_nop 1
    v_add_u32 v133, s97, v5
    v_mov_b32 v132, v10
    v_mov_b32 v233, 0
    v_mov_b32 v234, 0
    v_mov_b32 v235, 0
    s_add_u32 s15, s15, s13
    s_add_u32 s15, s15, 3584
    s_lshl_b32 s15, s15, 10
    v_bfe_u32 v6, v1, 4, 1
    v_bfe_u32 v7, v1, 2, 2
    v_lshrrev_b32 v8, 5, v1
    v_lshl_add_u32 v8, v8, 3, v7
    v_lshlrev_b32 v8, 7, v8
    v_lshl_add_u32 v8, v6, 13, v8
    v_lshrrev_b32 v7, 1, v7
    v_lshl_add_u32 v7, v6, 1, v7
    v_lshlrev_b32 v7, 1, v7
    v_and_b32 v9, 1, v1
    v_xor_b32 v7, v7, v9
    v_lshl_add_u32 v8, v7, 4, v8
    v_bfe_u32 v9, v1, 1, 1
    v_lshl_add_u32 v8, v9, 3, v8
    v_add_u32 v8, 0, v8
    v_xor_b32 v224, 0, v8
    v_xor_b32 v225, 32, v8
    v_xor_b32 v226, 64, v8
    v_xor_b32 v227, 96, v8
    v_bfe_u32 v7, v1, 2, 1
    v_bfe_u32 v8, v1, 3, 2
    v_and_b32 v9, 3, v1
    v_lshl_add_u32 v12, v8, 2, v9
    v_lshl_add_u32 v12, v7, 4, v12
    v_add_u32 v11, 128, v12
    v_cmp_gt_u32 vcc, 32, v1
    s_lshl_b32 s12, s4, 5
    s_nop 0
    v_cndmask_b32 v11, v11, v1, vcc
    v_add_u32 v12, s12, v12
    v_add_lshl_u32 v11, v11, s12, 2
    v_add_u32 v237, 155648, v11
    v_lshrrev_b32 v13, 5, v1
    v_lshlrev_b32 v13, 2, v13
    v_lshlrev_b32 v238, 4, v12
    v_bfe_u32 v8, v1, 3, 1
    v_lshl_add_u32 v9, v8, 2, v9
    v_lshl_add_u32 v9, v7, 3, v9
    v_lshl_add_u32 v13, v6, 7, v9
    v_lshlrev_b32 v13, 2, v13
    v_add_u32 v236, 156672, v13
    s_lshr_b32 s12, s4, 1
    s_mul_i32 s12, s12, 28
    v_min_u32 v7, 6, v1
    v_lshlrev_b32 v7, 2, v7
    v_add_u32 v7, s12, v7
    s_and_b32 s13, s4, 1
    s_lshl_b32 s12, s13, 7
    v_add_lshl_u32 v7, v7, s12, 6
    v_and_b32 v8, 1, v1
    v_lshlrev_b32 v8, 13, v8
    v_cmp_lt_u32 vcc, 31, v1
    s_lshl_b32 s91, s7, 14
    s_add_u32 s89, s91, 13631488
    v_cndmask_b32 v12, v7, v8, vcc
    s_add_u32 s91, s91, 13107200
    s_lshl_b32 s90, s7, 1
    s_add_u32 s90, s90, s13
    s_mul_i32 s90, s90, 56
    s_lshr_b32 s12, s4, 1
    s_mul_i32 s12, s12, 28
    s_add_u32 s90, s90, s12
    s_add_u32 s90, s90, 3584
    s_lshl_b32 s90, s90, 10
    v_bfe_u32 v10, v1, 2, 2
    v_lshrrev_b32 v13, 5, v1
    v_lshl_add_u32 v13, v13, 3, v10
    v_lshlrev_b32 v13, 7, v13
    v_lshrrev_b32 v10, 1, v10
    v_lshlrev_b32 v10, 2, v10
    v_bfe_u32 v11, v1, 4, 1
    v_lshl_add_u32 v10, v11, 1, v10
    v_bfe_u32 v11, v1, 1, 1
    v_add_u32 v10, v10, v11
    v_lshl_add_u32 v13, v10, 4, v13
    v_and_b32 v11, 1, v1
    v_lshl_add_u32 v13, v11, 3, v13
    s_lshr_b32 s12, s4, 1
    s_lshl_b32 s12, s12, 13
    s_add_u32 s12, s12, 98304
    v_add_u32 v9, s12, v13
    v_lshrrev_b32 v2, 3, v0
    v_and_b32 v11, 7, v0
    v_and_b32 v10, 7, v2
    v_xor_b32 v10, v10, v11
    v_lshlrev_b32 v10, 4, v10
    v_lshl_add_u32 v3, v2, 7, v10
    v_and_b32 v4, 0x23, v2
    v_bfe_u32 v10, v2, 2, 2
    v_lshl_or_b32 v4, v10, 3, v4
    v_bfe_u32 v10, v2, 4, 1
    v_lshl_or_b32 v4, v10, 2, v4
    v_and_b32 v10, 2, v4
    v_lshlrev_b32 v10, 2, v10
    v_and_or_b32 v10, v4, 7, v10
    v_xor_b32 v10, v10, v11
    v_lshlrev_b32 v10, 4, v10
    v_lshl_add_u32 v4, v4, 8, v10
    v_lshlrev_b32 v11, 4, v11
    s_movk_i32 s14, 1792
    v_mad_u32_u24 v2, v2, s14, v11
    s_mul_i32 s98, s7, 114688
    s_lshl_b32 s14, s8, 8
    s_add_u32 s98, s98, s14
    v_xor_b32 v10, 64, v9
    s_cmp_lt_u32 s4, 2
    s_mov_b32 s12, 16384
    s_cmov_b32 s12, 81920
    s_lshl_b32 s13, s13, 13
    s_add_u32 s12, s12, s13
    v_and_b32 v11, 7, v1
    v_and_b32 v13, 2, v1
    v_lshl_or_b32 v11, v13, 2, v11
    v_lshrrev_b32 v13, 5, v1
    v_xor_b32 v11, v11, v13
    v_lshlrev_b32 v11, 4, v11
    v_and_b32 v13, 31, v1
    v_lshl_add_u32 v13, v13, 8, v11
    v_add_u32 v13, s12, v13
    v_lshlrev_b32 v6, 4, v1
    v_and_b32 v14, 3, v1
    v_mul_u32_u24 v14, 260, v14
    v_add_u32 v14, 157696, v14
    s_lshl_b32 s12, s4, 8
    s_add_u32 s12, s12, 157696
    v_lshl_add_u32 v5, v1, 2, s12
    s_add_u32 m0, s97, 16384
    s_lshl_b32 s88, s81, 7
    buffer_load_dwordx4 v128, s[48:51], s88 offen  lds
    s_addk_i32 s88, 2560
    buffer_load_dwordx4 v129, s[48:51], s88 offen offset:1024  lds
    s_addk_i32 s88, 2560
    buffer_load_dwordx4 v128, s[48:51], s88 offen offset:2048  lds
    s_addk_i32 s88, 2560
    buffer_load_dwordx4 v129, s[48:51], s88 offen offset:3072  lds
    s_add_u32 m0, s94, 147456
    s_lshl_b32 s88, s81, 7
    buffer_load_dwordx4 v130, s[52:55], s88 offen  lds
    s_addk_i32 s88, 2560
    buffer_load_dwordx4 v131, s[52:55], s88 offen offset:1024  lds
    s_add_u32 m0, s97, 32768
    s_lshl_b32 s88, s82, 7
    buffer_load_dwordx4 v128, s[48:51], s88 offen  lds
    s_addk_i32 s88, 2560
    buffer_load_dwordx4 v129, s[48:51], s88 offen offset:1024  lds
    s_addk_i32 s88, 2560
    buffer_load_dwordx4 v128, s[48:51], s88 offen offset:2048  lds
    s_addk_i32 s88, 2560
    buffer_load_dwordx4 v129, s[48:51], s88 offen offset:3072  lds
    s_add_u32 m0, s94, 114688
    s_lshl_b32 s88, s82, 7
    buffer_load_dwordx4 v130, s[52:55], s88 offen  lds
    s_addk_i32 s88, 2560
    buffer_load_dwordx4 v131, s[52:55], s88 offen offset:1024  lds
    s_add_u32 m0, s97, 49152
    s_lshl_b32 s88, s83, 7
    buffer_load_dwordx4 v128, s[48:51], s88 offen  lds
    s_addk_i32 s88, 2560
    buffer_load_dwordx4 v129, s[48:51], s88 offen offset:1024  lds
    s_addk_i32 s88, 2560
    buffer_load_dwordx4 v128, s[48:51], s88 offen offset:2048  lds
    s_addk_i32 s88, 2560
    buffer_load_dwordx4 v129, s[48:51], s88 offen offset:3072  lds
    s_add_u32 m0, s94, 122880
    s_lshl_b32 s88, s83, 7
    buffer_load_dwordx4 v130, s[52:55], s88 offen  lds
    s_addk_i32 s88, 2560
    buffer_load_dwordx4 v131, s[52:55], s88 offen offset:1024  lds
    s_waitcnt lgkmcnt(0)
    s_mul_i32 s11, s11, 1664525
    s_add_u32 s11, s11, 1013904223
    v_add_u32 v136, 0, v133
    v_xor_b32 v137, 32, v136
    v_xor_b32 v138, 64, v136
    v_xor_b32 v139, 96, v136
    s_waitcnt vmcnt(14)
    s_waitcnt vmcnt(12)
    s_waitcnt lgkmcnt(0)
    s_barrier
    ds_read_b128 v[16:19], v136
    ds_read_b128 v[20:23], v137
    ds_read_b128 v[24:27], v138
    ds_read_b128 v[28:31], v139
    v_add_u32 v136, 16384, v133
    v_xor_b32 v137, 32, v136
    v_xor_b32 v138, 64, v136
    v_xor_b32 v139, 96, v136
    ds_read_b128 v[32:35], v136
    ds_read_b128 v[36:39], v137
    ds_read_b128 v[40:43], v138
    ds_read_b128 v[44:47], v139
    s_add_u32 m0, s97, 65536
    s_lshl_b32 s88, s84, 7
    buffer_load_dwordx4 v128, s[48:51], s88 offen  lds
    s_addk_i32 s88, 2560
    buffer_load_dwordx4 v129, s[48:51], s88 offen offset:1024  lds
    s_addk_i32 s88, 2560
    buffer_load_dwordx4 v128, s[48:51], s88 offen offset:2048  lds
    s_addk_i32 s88, 2560
    buffer_load_dwordx4 v129, s[48:51], s88 offen offset:3072  lds
    s_add_u32 m0, s94, 131072
    s_lshl_b32 s88, s84, 7
    buffer_load_dwordx4 v130, s[52:55], s88 offen  lds
    s_addk_i32 s88, 2560
    buffer_load_dwordx4 v131, s[52:55], s88 offen offset:1024  lds
    v_add_u32 v136, 32768, v133
    v_xor_b32 v137, 32, v136
    v_xor_b32 v138, 64, v136
    v_xor_b32 v139, 96, v136
    s_waitcnt vmcnt(14)
    s_waitcnt vmcnt(12)
    s_waitcnt lgkmcnt(0)
    s_barrier
    ds_read_b128 v[48:51], v136
    ds_read_b128 v[52:55], v137
    ds_read_b128 v[56:59], v138
    ds_read_b128 v[60:63], v139
    s_add_u32 m0, s97, 81920
    s_lshl_b32 s88, s85, 7
    buffer_load_dwordx4 v128, s[48:51], s88 offen  lds
    s_addk_i32 s88, 2560
    buffer_load_dwordx4 v129, s[48:51], s88 offen offset:1024  lds
    s_addk_i32 s88, 2560
    buffer_load_dwordx4 v128, s[48:51], s88 offen offset:2048  lds
    s_addk_i32 s88, 2560
    buffer_load_dwordx4 v129, s[48:51], s88 offen offset:3072  lds
    s_add_u32 m0, s94, 139264
    s_lshl_b32 s88, s85, 7
    buffer_load_dwordx4 v130, s[52:55], s88 offen  lds
    s_addk_i32 s88, 2560
    buffer_load_dwordx4 v131, s[52:55], s88 offen offset:1024  lds
    v_add_u32 v136, 49152, v133
    v_xor_b32 v137, 32, v136
    v_xor_b32 v138, 64, v136
    v_xor_b32 v139, 96, v136
    s_waitcnt vmcnt(14)
    s_waitcnt vmcnt(12)
    s_waitcnt lgkmcnt(0)
    s_barrier
    ds_read_b128 v[64:67], v136
    ds_read_b128 v[68:71], v137
    ds_read_b128 v[72:75], v138
    ds_read_b128 v[76:79], v139
    s_add_u32 m0, s97, 98304
    s_lshl_b32 s88, s86, 7
    buffer_load_dwordx4 v128, s[48:51], s88 offen  lds
    s_addk_i32 s88, 2560
    buffer_load_dwordx4 v129, s[48:51], s88 offen offset:1024  lds
    s_addk_i32 s88, 2560
    buffer_load_dwordx4 v128, s[48:51], s88 offen offset:2048  lds
    s_addk_i32 s88, 2560
    buffer_load_dwordx4 v129, s[48:51], s88 offen offset:3072  lds
    s_add_u32 m0, s94, 147456
    s_lshl_b32 s88, s86, 7
    buffer_load_dwordx4 v130, s[52:55], s88 offen  lds
    s_addk_i32 s88, 2560
    buffer_load_dwordx4 v131, s[52:55], s88 offen offset:1024  lds
    v_add_u32 v136, 65536, v133
    v_xor_b32 v137, 32, v136
    v_xor_b32 v138, 64, v136
    v_xor_b32 v139, 96, v136
    s_waitcnt vmcnt(14)
    s_waitcnt vmcnt(12)
    s_waitcnt lgkmcnt(0)
    s_barrier
    ds_read_b128 v[80:83], v136
    ds_read_b128 v[84:87], v137
    ds_read_b128 v[88:91], v138
    ds_read_b128 v[92:95], v139
    s_add_u32 m0, s97, 0
    s_mul_i32 s88, s80, 229376
    buffer_load_dwordx4 v132, s[56:59], s88 offen  lds
    s_addk_i32 s88, 27648
    buffer_load_dwordx4 v132, s[56:59], s88 offen offset:1024  lds
    s_addk_i32 s88, 27648
    buffer_load_dwordx4 v132, s[56:59], s88 offen offset:2048  lds
    s_addk_i32 s88, 27648
    buffer_load_dwordx4 v132, s[56:59], s88 offen offset:3072  lds
    v_add_u32 v136, 81920, v133
    v_xor_b32 v137, 32, v136
    v_xor_b32 v138, 64, v136
    v_xor_b32 v139, 96, v136
    s_waitcnt vmcnt(12)
    s_waitcnt vmcnt(10)
    s_waitcnt lgkmcnt(0)
    s_barrier
    ds_read_b128 v[96:99], v136
    ds_read_b128 v[100:103], v137
    ds_read_b128 v[104:107], v138
    ds_read_b128 v[108:111], v139
    s_add_u32 m0, s97, 16384
    s_mul_i32 s88, s81, 229376
    buffer_load_dwordx4 v132, s[56:59], s88 offen  lds
    s_addk_i32 s88, 27648
    buffer_load_dwordx4 v132, s[56:59], s88 offen offset:1024  lds
    s_addk_i32 s88, 27648
    buffer_load_dwordx4 v132, s[56:59], s88 offen offset:2048  lds
    s_addk_i32 s88, 27648
    buffer_load_dwordx4 v132, s[56:59], s88 offen offset:3072  lds
    s_add_u32 m0, s97, 32768
    s_mul_i32 s88, s82, 229376
    buffer_load_dwordx4 v132, s[56:59], s88 offen  lds
    s_addk_i32 s88, 27648
    buffer_load_dwordx4 v132, s[56:59], s88 offen offset:1024  lds
    s_addk_i32 s88, 27648
    buffer_load_dwordx4 v132, s[56:59], s88 offen offset:2048  lds
    s_addk_i32 s88, 27648
    buffer_load_dwordx4 v132, s[56:59], s88 offen offset:3072  lds
    v_add_u32 v136, 98304, v133
    v_xor_b32 v137, 32, v136
    v_xor_b32 v138, 64, v136
    v_xor_b32 v139, 96, v136
    s_waitcnt vmcnt(14)
    s_waitcnt vmcnt(12)
    s_waitcnt lgkmcnt(0)
    s_barrier
    ds_read_b128 v[112:115], v136
    ds_read_b128 v[116:119], v137
    ds_read_b128 v[120:123], v138
    ds_read_b128 v[124:127], v139
    s_add_u32 m0, s97, 49152
    s_mul_i32 s88, s83, 229376
    buffer_load_dwordx4 v132, s[56:59], s88 offen  lds
    s_addk_i32 s88, 27648
    buffer_load_dwordx4 v132, s[56:59], s88 offen offset:1024  lds
    s_addk_i32 s88, 27648
    buffer_load_dwordx4 v132, s[56:59], s88 offen offset:2048  lds
    s_addk_i32 s88, 27648
    buffer_load_dwordx4 v132, s[56:59], s88 offen offset:3072  lds
    s_waitcnt lgkmcnt(0)
    s_barrier
    s_add_u32 m0, s97, 114688
    s_mul_i32 s88, s84, 229376
    buffer_load_dwordx4 v132, s[56:59], s88 offen  lds
    s_addk_i32 s88, 27648
    buffer_load_dwordx4 v132, s[56:59], s88 offen offset:1024  lds
    s_addk_i32 s88, 27648
    buffer_load_dwordx4 v132, s[56:59], s88 offen offset:2048  lds
    s_addk_i32 s88, 27648
    buffer_load_dwordx4 v132, s[56:59], s88 offen offset:3072  lds
    s_add_u32 m0, s97, 65536
    s_mul_i32 s88, s85, 229376
    buffer_load_dwordx4 v132, s[56:59], s88 offen  lds
    s_addk_i32 s88, 27648
    buffer_load_dwordx4 v132, s[56:59], s88 offen offset:1024  lds
    s_addk_i32 s88, 27648
    buffer_load_dwordx4 v132, s[56:59], s88 offen offset:2048  lds
    s_addk_i32 s88, 27648
    buffer_load_dwordx4 v132, s[56:59], s88 offen offset:3072  lds
    s_add_u32 m0, s97, 81920
    s_mul_i32 s88, s86, 229376
    buffer_load_dwordx4 v132, s[56:59], s88 offen  lds
    s_addk_i32 s88, 27648
    buffer_load_dwordx4 v132, s[56:59], s88 offen offset:1024  lds
    s_addk_i32 s88, 27648
    buffer_load_dwordx4 v132, s[56:59], s88 offen offset:2048  lds
    s_addk_i32 s88, 27648
    buffer_load_dwordx4 v132, s[56:59], s88 offen offset:3072  lds
    s_lshl_b32 s92, s5, 11
    s_add_u32 s92, s92, 11796480
    buffer_load_dwordx2 v[228:229], v238, s[68:71], s92 offen sc1
    s_waitcnt vmcnt(21)
    s_waitcnt lgkmcnt(0)
    s_barrier
    ds_read_b64_tr_b16 v[192:193], v224 offset:0
    ds_read_b64_tr_b16 v[194:195], v224 offset:512
    ds_read_b64_tr_b16 v[196:197], v225 offset:0
    ds_read_b64_tr_b16 v[198:199], v225 offset:512
    ds_read_b64_tr_b16 v[200:201], v226 offset:0
    ds_read_b64_tr_b16 v[202:203], v226 offset:512
    ds_read_b64_tr_b16 v[204:205], v227 offset:0
    ds_read_b64_tr_b16 v[206:207], v227 offset:512
    s_waitcnt lgkmcnt(6)
    v_mfma_f32_32x32x16_bf16 v[128:143], v[192:195], v[16:19], 0
    ds_read_b64_tr_b16 v[208:209], v224 offset:2048
    ds_read_b64_tr_b16 v[210:211], v224 offset:2560
    s_waitcnt lgkmcnt(6)
    v_mfma_f32_32x32x16_bf16 v[144:159], v[196:199], v[16:19], 0
    ds_read_b64_tr_b16 v[212:213], v225 offset:2048
    ds_read_b64_tr_b16 v[214:215], v225 offset:2560
    s_waitcnt lgkmcnt(6)
    v_mfma_f32_32x32x16_bf16 v[160:175], v[200:203], v[16:19], 0
    ds_read_b64_tr_b16 v[216:217], v226 offset:2048
    ds_read_b64_tr_b16 v[218:219], v226 offset:2560
    s_waitcnt lgkmcnt(6)
    v_mfma_f32_32x32x16_bf16 v[176:191], v[204:207], v[16:19], 0
    ds_read_b64_tr_b16 v[220:221], v227 offset:2048
    ds_read_b64_tr_b16 v[222:223], v227 offset:2560
    s_waitcnt lgkmcnt(6)
    v_mfma_f32_32x32x16_bf16 v[128:143], v[208:211], v[20:23], v[128:143]
    ds_read_b64_tr_b16 v[192:193], v224 offset:4096
    ds_read_b64_tr_b16 v[194:195], v224 offset:4608
    s_waitcnt lgkmcnt(6)
    v_mfma_f32_32x32x16_bf16 v[144:159], v[212:215], v[20:23], v[144:159]
    ds_read_b64_tr_b16 v[196:197], v225 offset:4096
    ds_read_b64_tr_b16 v[198:199], v225 offset:4608
    s_waitcnt lgkmcnt(6)
    v_mfma_f32_32x32x16_bf16 v[160:175], v[216:219], v[20:23], v[160:175]
    ds_read_b64_tr_b16 v[200:201], v226 offset:4096
    ds_read_b64_tr_b16 v[202:203], v226 offset:4608
    s_waitcnt lgkmcnt(6)
    v_mfma_f32_32x32x16_bf16 v[176:191], v[220:223], v[20:23], v[176:191]
    ds_read_b64_tr_b16 v[204:205], v227 offset:4096
    ds_read_b64_tr_b16 v[206:207], v227 offset:4608
    s_waitcnt lgkmcnt(6)
    v_mfma_f32_32x32x16_bf16 v[128:143], v[192:195], v[24:27], v[128:143]
    ds_read_b64_tr_b16 v[208:209], v224 offset:6144
    ds_read_b64_tr_b16 v[210:211], v224 offset:6656
    s_waitcnt lgkmcnt(6)
    v_mfma_f32_32x32x16_bf16 v[144:159], v[196:199], v[24:27], v[144:159]
    ds_read_b64_tr_b16 v[212:213], v225 offset:6144
    ds_read_b64_tr_b16 v[214:215], v225 offset:6656
    s_waitcnt lgkmcnt(6)
    v_mfma_f32_32x32x16_bf16 v[160:175], v[200:203], v[24:27], v[160:175]
    ds_read_b64_tr_b16 v[216:217], v226 offset:6144
    ds_read_b64_tr_b16 v[218:219], v226 offset:6656
    s_waitcnt lgkmcnt(6)
    v_mfma_f32_32x32x16_bf16 v[176:191], v[204:207], v[24:27], v[176:191]
    ds_read_b64_tr_b16 v[220:221], v227 offset:6144
    ds_read_b64_tr_b16 v[222:223], v227 offset:6656
    v_add_u32 v224, 16384, v224
    v_add_u32 v225, 16384, v225
    v_add_u32 v226, 16384, v226
    v_add_u32 v227, 16384, v227
    s_waitcnt lgkmcnt(6)
    v_mfma_f32_32x32x16_bf16 v[128:143], v[208:211], v[28:31], v[128:143]
    ds_read_b64_tr_b16 v[192:193], v224 offset:0
    ds_read_b64_tr_b16 v[194:195], v224 offset:512
    s_waitcnt lgkmcnt(6)
    v_mfma_f32_32x32x16_bf16 v[144:159], v[212:215], v[28:31], v[144:159]
    ds_read_b64_tr_b16 v[196:197], v225 offset:0
    ds_read_b64_tr_b16 v[198:199], v225 offset:512
    s_waitcnt lgkmcnt(6)
    v_mfma_f32_32x32x16_bf16 v[160:175], v[216:219], v[28:31], v[160:175]
    ds_read_b64_tr_b16 v[200:201], v226 offset:0
    ds_read_b64_tr_b16 v[202:203], v226 offset:512
    s_waitcnt lgkmcnt(6)
    v_mfma_f32_32x32x16_bf16 v[176:191], v[220:223], v[28:31], v[176:191]
    s_waitcnt vmcnt(17)
    s_barrier
    ds_read_b64_tr_b16 v[204:205], v227 offset:0
    ds_read_b64_tr_b16 v[206:207], v227 offset:512
    s_waitcnt lgkmcnt(6)
    v_mfma_f32_32x32x16_bf16 v[128:143], v[192:195], v[32:35], v[128:143]
    ds_read_b64_tr_b16 v[208:209], v224 offset:2048
    ds_read_b64_tr_b16 v[210:211], v224 offset:2560
    s_waitcnt lgkmcnt(6)
    v_mfma_f32_32x32x16_bf16 v[144:159], v[196:199], v[32:35], v[144:159]
    ds_read_b64_tr_b16 v[212:213], v225 offset:2048
    ds_read_b64_tr_b16 v[214:215], v225 offset:2560
    s_waitcnt lgkmcnt(6)
    v_mfma_f32_32x32x16_bf16 v[160:175], v[200:203], v[32:35], v[160:175]
    ds_read_b64_tr_b16 v[216:217], v226 offset:2048
    ds_read_b64_tr_b16 v[218:219], v226 offset:2560
    s_waitcnt lgkmcnt(6)
    v_mfma_f32_32x32x16_bf16 v[176:191], v[204:207], v[32:35], v[176:191]
    ds_read_b64_tr_b16 v[220:221], v227 offset:2048
    ds_read_b64_tr_b16 v[222:223], v227 offset:2560
    s_waitcnt lgkmcnt(6)
    v_mfma_f32_32x32x16_bf16 v[128:143], v[208:211], v[36:39], v[128:143]
    ds_read_b64_tr_b16 v[192:193], v224 offset:4096
    ds_read_b64_tr_b16 v[194:195], v224 offset:4608
    s_waitcnt lgkmcnt(6)
    v_mfma_f32_32x32x16_bf16 v[144:159], v[212:215], v[36:39], v[144:159]
    ds_read_b64_tr_b16 v[196:197], v225 offset:4096
    ds_read_b64_tr_b16 v[198:199], v225 offset:4608
    s_waitcnt lgkmcnt(6)
    v_mfma_f32_32x32x16_bf16 v[160:175], v[216:219], v[36:39], v[160:175]
    ds_read_b64_tr_b16 v[200:201], v226 offset:4096
    ds_read_b64_tr_b16 v[202:203], v226 offset:4608
    s_waitcnt lgkmcnt(6)
    v_mfma_f32_32x32x16_bf16 v[176:191], v[220:223], v[36:39], v[176:191]
    ds_read_b64_tr_b16 v[204:205], v227 offset:4096
    ds_read_b64_tr_b16 v[206:207], v227 offset:4608
    s_waitcnt lgkmcnt(6)
    v_mfma_f32_32x32x16_bf16 v[128:143], v[192:195], v[40:43], v[128:143]
    ds_read_b64_tr_b16 v[208:209], v224 offset:6144
    ds_read_b64_tr_b16 v[210:211], v224 offset:6656
    s_waitcnt lgkmcnt(6)
    v_mfma_f32_32x32x16_bf16 v[144:159], v[196:199], v[40:43], v[144:159]
    ds_read_b64_tr_b16 v[212:213], v225 offset:6144
    ds_read_b64_tr_b16 v[214:215], v225 offset:6656
    s_waitcnt lgkmcnt(6)
    v_mfma_f32_32x32x16_bf16 v[160:175], v[200:203], v[40:43], v[160:175]
    ds_read_b64_tr_b16 v[216:217], v226 offset:6144
    ds_read_b64_tr_b16 v[218:219], v226 offset:6656
    s_waitcnt lgkmcnt(6)
    v_mfma_f32_32x32x16_bf16 v[176:191], v[204:207], v[40:43], v[176:191]
    ds_read_b64_tr_b16 v[220:221], v227 offset:6144
    ds_read_b64_tr_b16 v[222:223], v227 offset:6656
    v_add_u32 v224, 16384, v224
    v_add_u32 v225, 16384, v225
    v_add_u32 v226, 16384, v226
    v_add_u32 v227, 16384, v227
    s_waitcnt lgkmcnt(6)
    v_mfma_f32_32x32x16_bf16 v[128:143], v[208:211], v[44:47], v[128:143]
    ds_read_b64_tr_b16 v[192:193], v224 offset:0
    ds_read_b64_tr_b16 v[194:195], v224 offset:512
    s_waitcnt lgkmcnt(6)
    v_mfma_f32_32x32x16_bf16 v[144:159], v[212:215], v[44:47], v[144:159]
    ds_read_b64_tr_b16 v[196:197], v225 offset:0
    ds_read_b64_tr_b16 v[198:199], v225 offset:512
    s_waitcnt lgkmcnt(6)
    v_mfma_f32_32x32x16_bf16 v[160:175], v[216:219], v[44:47], v[160:175]
    ds_read_b64_tr_b16 v[200:201], v226 offset:0
    ds_read_b64_tr_b16 v[202:203], v226 offset:512
    s_waitcnt lgkmcnt(6)
    v_mfma_f32_32x32x16_bf16 v[176:191], v[220:223], v[44:47], v[176:191]
    s_waitcnt vmcnt(1)
    s_barrier
    ds_read_b64_tr_b16 v[204:205], v227 offset:0
    ds_read_b64_tr_b16 v[206:207], v227 offset:512
    s_waitcnt lgkmcnt(6)
    v_mfma_f32_32x32x16_bf16 v[128:143], v[192:195], v[48:51], v[128:143]
    ds_read_b64_tr_b16 v[208:209], v224 offset:2048
    ds_read_b64_tr_b16 v[210:211], v224 offset:2560
    s_waitcnt lgkmcnt(6)
    v_mfma_f32_32x32x16_bf16 v[144:159], v[196:199], v[48:51], v[144:159]
    ds_read_b64_tr_b16 v[212:213], v225 offset:2048
    ds_read_b64_tr_b16 v[214:215], v225 offset:2560
    s_waitcnt lgkmcnt(6)
    v_mfma_f32_32x32x16_bf16 v[160:175], v[200:203], v[48:51], v[160:175]
    ds_read_b64_tr_b16 v[216:217], v226 offset:2048
    ds_read_b64_tr_b16 v[218:219], v226 offset:2560
    s_waitcnt lgkmcnt(6)
    v_mfma_f32_32x32x16_bf16 v[176:191], v[204:207], v[48:51], v[176:191]
    ds_read_b64_tr_b16 v[220:221], v227 offset:2048
    ds_read_b64_tr_b16 v[222:223], v227 offset:2560
    s_waitcnt lgkmcnt(6)
    v_mfma_f32_32x32x16_bf16 v[128:143], v[208:211], v[52:55], v[128:143]
    ds_read_b64_tr_b16 v[192:193], v224 offset:4096
    ds_read_b64_tr_b16 v[194:195], v224 offset:4608
    s_waitcnt lgkmcnt(6)
    v_mfma_f32_32x32x16_bf16 v[144:159], v[212:215], v[52:55], v[144:159]
    ds_read_b64_tr_b16 v[196:197], v225 offset:4096
    ds_read_b64_tr_b16 v[198:199], v225 offset:4608
    s_waitcnt lgkmcnt(6)
    v_mfma_f32_32x32x16_bf16 v[160:175], v[216:219], v[52:55], v[160:175]
    ds_read_b64_tr_b16 v[200:201], v226 offset:4096
    ds_read_b64_tr_b16 v[202:203], v226 offset:4608
    s_waitcnt lgkmcnt(6)
    v_mfma_f32_32x32x16_bf16 v[176:191], v[220:223], v[52:55], v[176:191]
    ds_read_b64_tr_b16 v[204:205], v227 offset:4096
    ds_read_b64_tr_b16 v[206:207], v227 offset:4608
    s_waitcnt lgkmcnt(6)
    v_mfma_f32_32x32x16_bf16 v[128:143], v[192:195], v[56:59], v[128:143]
    ds_read_b64_tr_b16 v[208:209], v224 offset:6144
    ds_read_b64_tr_b16 v[210:211], v224 offset:6656
    s_waitcnt lgkmcnt(6)
    v_mfma_f32_32x32x16_bf16 v[144:159], v[196:199], v[56:59], v[144:159]
    ds_read_b64_tr_b16 v[212:213], v225 offset:6144
    ds_read_b64_tr_b16 v[214:215], v225 offset:6656
    s_waitcnt lgkmcnt(6)
    v_mfma_f32_32x32x16_bf16 v[160:175], v[200:203], v[56:59], v[160:175]
    ds_read_b64_tr_b16 v[216:217], v226 offset:6144
    ds_read_b64_tr_b16 v[218:219], v226 offset:6656
    s_waitcnt lgkmcnt(6)
    v_mfma_f32_32x32x16_bf16 v[176:191], v[204:207], v[56:59], v[176:191]
    ds_read_b64_tr_b16 v[220:221], v227 offset:6144
    ds_read_b64_tr_b16 v[222:223], v227 offset:6656
    v_add_u32 v224, 16384, v224
    v_add_u32 v225, 16384, v225
    v_add_u32 v226, 16384, v226
    v_add_u32 v227, 16384, v227
    s_waitcnt lgkmcnt(6)
    v_mfma_f32_32x32x16_bf16 v[128:143], v[208:211], v[60:63], v[128:143]
    ds_read_b64_tr_b16 v[192:193], v224 offset:0
    ds_read_b64_tr_b16 v[194:195], v224 offset:512
    s_waitcnt lgkmcnt(6)
    v_mfma_f32_32x32x16_bf16 v[144:159], v[212:215], v[60:63], v[144:159]
    ds_read_b64_tr_b16 v[196:197], v225 offset:0
    ds_read_b64_tr_b16 v[198:199], v225 offset:512
    s_waitcnt lgkmcnt(6)
    v_mfma_f32_32x32x16_bf16 v[160:175], v[216:219], v[60:63], v[160:175]
    ds_read_b64_tr_b16 v[200:201], v226 offset:0
    ds_read_b64_tr_b16 v[202:203], v226 offset:512
    s_waitcnt lgkmcnt(6)
    v_mfma_f32_32x32x16_bf16 v[176:191], v[220:223], v[60:63], v[176:191]
    s_barrier
    ds_read_b64_tr_b16 v[204:205], v227 offset:0
    ds_read_b64_tr_b16 v[206:207], v227 offset:512
    s_waitcnt lgkmcnt(6)
    v_mfma_f32_32x32x16_bf16 v[128:143], v[192:195], v[64:67], v[128:143]
    ds_read_b64_tr_b16 v[208:209], v224 offset:2048
    ds_read_b64_tr_b16 v[210:211], v224 offset:2560
    s_waitcnt vmcnt(0)
    v_cmp_ne_u32 vcc, s11, v229
    s_cbranch_vccnz L_ggm_slow
L_ggm_ok:
    v_cmp_gt_u32 vcc, 32, v1
    s_waitcnt lgkmcnt(6)
    v_mfma_f32_32x32x16_bf16 v[144:159], v[196:199], v[64:67], v[144:159]
    ds_read_b64_tr_b16 v[212:213], v225 offset:2048
    ds_read_b64_tr_b16 v[214:215], v225 offset:2560
    v_cndmask_b32 v232, 0, v228, vcc
    s_waitcnt lgkmcnt(6)
    v_mfma_f32_32x32x16_bf16 v[160:175], v[200:203], v[64:67], v[160:175]
    ds_read_b64_tr_b16 v[216:217], v226 offset:2048
    ds_read_b64_tr_b16 v[218:219], v226 offset:2560
    s_waitcnt lgkmcnt(6)
    v_mfma_f32_32x32x16_bf16 v[176:191], v[204:207], v[64:67], v[176:191]
    ds_read_b64_tr_b16 v[220:221], v227 offset:2048
    ds_read_b64_tr_b16 v[222:223], v227 offset:2560
    s_waitcnt lgkmcnt(6)
    v_mfma_f32_32x32x16_bf16 v[128:143], v[208:211], v[68:71], v[128:143]
    ds_read_b64_tr_b16 v[192:193], v224 offset:4096
    ds_read_b64_tr_b16 v[194:195], v224 offset:4608
    s_waitcnt lgkmcnt(6)
    v_mfma_f32_32x32x16_bf16 v[144:159], v[212:215], v[68:71], v[144:159]
    ds_read_b64_tr_b16 v[196:197], v225 offset:4096
    ds_read_b64_tr_b16 v[198:199], v225 offset:4608
    s_waitcnt lgkmcnt(6)
    v_mfma_f32_32x32x16_bf16 v[160:175], v[216:219], v[68:71], v[160:175]
    ds_read_b64_tr_b16 v[200:201], v226 offset:4096
    ds_read_b64_tr_b16 v[202:203], v226 offset:4608
    s_waitcnt lgkmcnt(6)
    v_mfma_f32_32x32x16_bf16 v[176:191], v[220:223], v[68:71], v[176:191]
    ds_read_b64_tr_b16 v[204:205], v227 offset:4096
    ds_read_b64_tr_b16 v[206:207], v227 offset:4608
    s_waitcnt lgkmcnt(6)
    v_mfma_f32_32x32x16_bf16 v[128:143], v[192:195], v[72:75], v[128:143]
    ds_read_b64_tr_b16 v[208:209], v224 offset:6144
    ds_read_b64_tr_b16 v[210:211], v224 offset:6656
    s_waitcnt lgkmcnt(6)
    v_mfma_f32_32x32x16_bf16 v[144:159], v[196:199], v[72:75], v[144:159]
    ds_read_b64_tr_b16 v[212:213], v225 offset:6144
    ds_read_b64_tr_b16 v[214:215], v225 offset:6656
    s_waitcnt lgkmcnt(6)
    v_mfma_f32_32x32x16_bf16 v[160:175], v[200:203], v[72:75], v[160:175]
    ds_read_b64_tr_b16 v[216:217], v226 offset:6144
    ds_read_b64_tr_b16 v[218:219], v226 offset:6656
    s_waitcnt lgkmcnt(6)
    v_mfma_f32_32x32x16_bf16 v[176:191], v[204:207], v[72:75], v[176:191]
    ds_read_b64_tr_b16 v[220:221], v227 offset:6144
    ds_read_b64_tr_b16 v[222:223], v227 offset:6656
    v_add_u32 v224, 65536, v224
    v_add_u32 v225, 65536, v225
    v_add_u32 v226, 65536, v226
    v_add_u32 v227, 65536, v227
    s_waitcnt lgkmcnt(6)
    v_mfma_f32_32x32x16_bf16 v[128:143], v[208:211], v[76:79], v[128:143]
    ds_read_b64_tr_b16 v[192:193], v224 offset:0
    ds_read_b64_tr_b16 v[194:195], v224 offset:512
    s_waitcnt lgkmcnt(6)
    v_mfma_f32_32x32x16_bf16 v[144:159], v[212:215], v[76:79], v[144:159]
    ds_read_b64_tr_b16 v[196:197], v225 offset:0
    ds_read_b64_tr_b16 v[198:199], v225 offset:512
    s_waitcnt lgkmcnt(6)
    v_mfma_f32_32x32x16_bf16 v[160:175], v[216:219], v[76:79], v[160:175]
    ds_read_b64_tr_b16 v[200:201], v226 offset:0
    ds_read_b64_tr_b16 v[202:203], v226 offset:512
    s_waitcnt lgkmcnt(6)
    v_mfma_f32_32x32x16_bf16 v[176:191], v[220:223], v[76:79], v[176:191]
    s_barrier
    ds_read_b64_tr_b16 v[204:205], v227 offset:0
    ds_read_b64_tr_b16 v[206:207], v227 offset:512
    s_waitcnt lgkmcnt(6)
    v_mfma_f32_32x32x16_bf16 v[128:143], v[192:195], v[80:83], v[128:143]
    ds_read_b64_tr_b16 v[208:209], v224 offset:2048
    ds_read_b64_tr_b16 v[210:211], v224 offset:2560
    s_waitcnt lgkmcnt(6)
    v_mfma_f32_32x32x16_bf16 v[144:159], v[196:199], v[80:83], v[144:159]
    ds_read_b64_tr_b16 v[212:213], v225 offset:2048
    ds_read_b64_tr_b16 v[214:215], v225 offset:2560
    s_waitcnt lgkmcnt(6)
    v_mfma_f32_32x32x16_bf16 v[160:175], v[200:203], v[80:83], v[160:175]
    ds_read_b64_tr_b16 v[216:217], v226 offset:2048
    ds_read_b64_tr_b16 v[218:219], v226 offset:2560
    s_waitcnt lgkmcnt(6)
    v_mfma_f32_32x32x16_bf16 v[176:191], v[204:207], v[80:83], v[176:191]
    ds_read_b64_tr_b16 v[220:221], v227 offset:2048
    ds_read_b64_tr_b16 v[222:223], v227 offset:2560
    s_waitcnt lgkmcnt(6)
    v_mfma_f32_32x32x16_bf16 v[128:143], v[208:211], v[84:87], v[128:143]
    ds_read_b64_tr_b16 v[192:193], v224 offset:4096
    ds_read_b64_tr_b16 v[194:195], v224 offset:4608
    s_waitcnt lgkmcnt(6)
    v_mfma_f32_32x32x16_bf16 v[144:159], v[212:215], v[84:87], v[144:159]
    ds_read_b64_tr_b16 v[196:197], v225 offset:4096
    ds_read_b64_tr_b16 v[198:199], v225 offset:4608
    s_waitcnt lgkmcnt(6)
    v_mfma_f32_32x32x16_bf16 v[160:175], v[216:219], v[84:87], v[160:175]
    ds_read_b64_tr_b16 v[200:201], v226 offset:4096
    ds_read_b64_tr_b16 v[202:203], v226 offset:4608
    s_waitcnt lgkmcnt(6)
    v_mfma_f32_32x32x16_bf16 v[176:191], v[220:223], v[84:87], v[176:191]
    ds_read_b64_tr_b16 v[204:205], v227 offset:4096
    ds_read_b64_tr_b16 v[206:207], v227 offset:4608
    s_waitcnt lgkmcnt(6)
    v_mfma_f32_32x32x16_bf16 v[128:143], v[192:195], v[88:91], v[128:143]
    ds_read_b64_tr_b16 v[208:209], v224 offset:6144
    ds_read_b64_tr_b16 v[210:211], v224 offset:6656
    s_waitcnt lgkmcnt(6)
    v_mfma_f32_32x32x16_bf16 v[144:159], v[196:199], v[88:91], v[144:159]
    ds_read_b64_tr_b16 v[212:213], v225 offset:6144
    ds_read_b64_tr_b16 v[214:215], v225 offset:6656
    s_waitcnt lgkmcnt(6)
    v_mfma_f32_32x32x16_bf16 v[160:175], v[200:203], v[88:91], v[160:175]
    ds_read_b64_tr_b16 v[216:217], v226 offset:6144
    ds_read_b64_tr_b16 v[218:219], v226 offset:6656
    s_waitcnt lgkmcnt(6)
    v_mfma_f32_32x32x16_bf16 v[176:191], v[204:207], v[88:91], v[176:191]
    ds_read_b64_tr_b16 v[220:221], v227 offset:6144
    ds_read_b64_tr_b16 v[222:223], v227 offset:6656
    v_add_u32 v224, 4294918144, v224
    v_add_u32 v225, 4294918144, v225
    v_add_u32 v226, 4294918144, v226
    v_add_u32 v227, 4294918144, v227
    s_waitcnt lgkmcnt(6)
    v_mfma_f32_32x32x16_bf16 v[128:143], v[208:211], v[92:95], v[128:143]
    ds_read_b64_tr_b16 v[192:193], v224 offset:0
    ds_read_b64_tr_b16 v[194:195], v224 offset:512
    s_waitcnt lgkmcnt(6)
    v_mfma_f32_32x32x16_bf16 v[144:159], v[212:215], v[92:95], v[144:159]
    ds_read_b64_tr_b16 v[196:197], v225 offset:0
    ds_read_b64_tr_b16 v[198:199], v225 offset:512
    s_waitcnt lgkmcnt(6)
    v_mfma_f32_32x32x16_bf16 v[160:175], v[216:219], v[92:95], v[160:175]
    ds_read_b64_tr_b16 v[200:201], v226 offset:0
    ds_read_b64_tr_b16 v[202:203], v226 offset:512
    s_waitcnt lgkmcnt(6)
    v_mfma_f32_32x32x16_bf16 v[176:191], v[220:223], v[92:95], v[176:191]
    s_barrier
    ds_read_b64_tr_b16 v[204:205], v227 offset:0
    ds_read_b64_tr_b16 v[206:207], v227 offset:512
    s_waitcnt lgkmcnt(6)
    v_mfma_f32_32x32x16_bf16 v[128:143], v[192:195], v[96:99], v[128:143]
    ds_read_b64_tr_b16 v[208:209], v224 offset:2048
    ds_read_b64_tr_b16 v[210:211], v224 offset:2560
    s_waitcnt lgkmcnt(6)
    v_mfma_f32_32x32x16_bf16 v[144:159], v[196:199], v[96:99], v[144:159]
    ds_read_b64_tr_b16 v[212:213], v225 offset:2048
    ds_read_b64_tr_b16 v[214:215], v225 offset:2560
    s_waitcnt lgkmcnt(6)
    v_mfma_f32_32x32x16_bf16 v[160:175], v[200:203], v[96:99], v[160:175]
    ds_read_b64_tr_b16 v[216:217], v226 offset:2048
    ds_read_b64_tr_b16 v[218:219], v226 offset:2560
    s_waitcnt lgkmcnt(6)
    v_mfma_f32_32x32x16_bf16 v[176:191], v[204:207], v[96:99], v[176:191]
    ds_read_b64_tr_b16 v[220:221], v227 offset:2048
    ds_read_b64_tr_b16 v[222:223], v227 offset:2560
    s_waitcnt lgkmcnt(6)
    v_mfma_f32_32x32x16_bf16 v[128:143], v[208:211], v[100:103], v[128:143]
    ds_read_b64_tr_b16 v[192:193], v224 offset:4096
    ds_read_b64_tr_b16 v[194:195], v224 offset:4608
    s_waitcnt lgkmcnt(6)
    v_mfma_f32_32x32x16_bf16 v[144:159], v[212:215], v[100:103], v[144:159]
    ds_read_b64_tr_b16 v[196:197], v225 offset:4096
    ds_read_b64_tr_b16 v[198:199], v225 offset:4608
    s_waitcnt lgkmcnt(6)
    v_mfma_f32_32x32x16_bf16 v[160:175], v[216:219], v[100:103], v[160:175]
    ds_read_b64_tr_b16 v[200:201], v226 offset:4096
    ds_read_b64_tr_b16 v[202:203], v226 offset:4608
    s_waitcnt lgkmcnt(6)
    v_mfma_f32_32x32x16_bf16 v[176:191], v[220:223], v[100:103], v[176:191]
    ds_read_b64_tr_b16 v[204:205], v227 offset:4096
    ds_read_b64_tr_b16 v[206:207], v227 offset:4608
    s_waitcnt lgkmcnt(6)
    v_mfma_f32_32x32x16_bf16 v[128:143], v[192:195], v[104:107], v[128:143]
    ds_read_b64_tr_b16 v[208:209], v224 offset:6144
    ds_read_b64_tr_b16 v[210:211], v224 offset:6656
    s_waitcnt lgkmcnt(6)
    v_mfma_f32_32x32x16_bf16 v[144:159], v[196:199], v[104:107], v[144:159]
    ds_read_b64_tr_b16 v[212:213], v225 offset:6144
    ds_read_b64_tr_b16 v[214:215], v225 offset:6656
    s_waitcnt lgkmcnt(6)
    v_mfma_f32_32x32x16_bf16 v[160:175], v[200:203], v[104:107], v[160:175]
    ds_read_b64_tr_b16 v[216:217], v226 offset:6144
    ds_read_b64_tr_b16 v[218:219], v226 offset:6656
    s_waitcnt lgkmcnt(6)
    v_mfma_f32_32x32x16_bf16 v[176:191], v[204:207], v[104:107], v[176:191]
    ds_read_b64_tr_b16 v[220:221], v227 offset:6144
    ds_read_b64_tr_b16 v[222:223], v227 offset:6656
    v_add_u32 v224, 16384, v224
    v_add_u32 v225, 16384, v225
    v_add_u32 v226, 16384, v226
    v_add_u32 v227, 16384, v227
    s_waitcnt lgkmcnt(6)
    v_mfma_f32_32x32x16_bf16 v[128:143], v[208:211], v[108:111], v[128:143]
    ds_read_b64_tr_b16 v[192:193], v224 offset:0
    ds_read_b64_tr_b16 v[194:195], v224 offset:512
    v_mov_b32 v241, 0
    v_mov_b32 v242, 0
    v_mov_b32 v243, 0
    s_waitcnt lgkmcnt(6)
    v_mfma_f32_32x32x16_bf16 v[144:159], v[212:215], v[108:111], v[144:159]
    ds_read_b64_tr_b16 v[196:197], v225 offset:0
    ds_read_b64_tr_b16 v[198:199], v225 offset:512
    v_mov_b32 v245, 0
    v_mov_b32 v246, 0
    v_mov_b32 v247, 0
    s_waitcnt lgkmcnt(6)
    v_mfma_f32_32x32x16_bf16 v[160:175], v[216:219], v[108:111], v[160:175]
    ds_read_b64_tr_b16 v[200:201], v226 offset:0
    ds_read_b64_tr_b16 v[202:203], v226 offset:512
    v_mov_b32 v249, 0
    v_mov_b32 v250, 0
    v_mov_b32 v251, 0
    s_waitcnt lgkmcnt(6)
    v_mfma_f32_32x32x16_bf16 v[176:191], v[220:223], v[108:111], v[176:191]
    s_barrier
    ds_read_b64_tr_b16 v[204:205], v227 offset:0
    ds_read_b64_tr_b16 v[206:207], v227 offset:512
    v_mov_b32 v253, 0
    v_mov_b32 v254, 0
    v_mov_b32 v255, 0
    s_waitcnt lgkmcnt(6)
    v_mfma_f32_32x32x16_bf16 v[128:143], v[192:195], v[112:115], v[128:143]
    ds_read_b32 v240, v236 offset:0
    ds_read_b64_tr_b16 v[208:209], v224 offset:2048
    ds_read_b64_tr_b16 v[210:211], v224 offset:2560
    s_waitcnt lgkmcnt(7)
    v_mfma_f32_32x32x16_bf16 v[144:159], v[196:199], v[112:115], v[144:159]
    ds_read_b32 v244, v236 offset:64
    ds_read_b64_tr_b16 v[212:213], v225 offset:2048
    ds_read_b64_tr_b16 v[214:215], v225 offset:2560
    s_waitcnt lgkmcnt(8)
    v_mfma_f32_32x32x16_bf16 v[160:175], v[200:203], v[112:115], v[160:175]
    ds_read_b32 v248, v236 offset:128
    ds_read_b64_tr_b16 v[216:217], v226 offset:2048
    ds_read_b64_tr_b16 v[218:219], v226 offset:2560
    s_waitcnt lgkmcnt(9)
    v_mfma_f32_32x32x16_bf16 v[176:191], v[204:207], v[112:115], v[176:191]
    ds_read_b32 v252, v236 offset:192
    ds_read_b64_tr_b16 v[220:221], v227 offset:2048
    ds_read_b64_tr_b16 v[222:223], v227 offset:2560
    s_waitcnt lgkmcnt(9)
    v_mfma_f32_32x32x16_bf16 v[128:143], v[208:211], v[116:119], v[128:143]
    ds_read_b64_tr_b16 v[192:193], v224 offset:4096
    ds_read_b64_tr_b16 v[194:195], v224 offset:4608
    s_waitcnt lgkmcnt(8)
    v_mfma_f32_32x32x16_bf16 v[144:159], v[212:215], v[116:119], v[144:159]
    ds_read_b64_tr_b16 v[196:197], v225 offset:4096
    ds_read_b64_tr_b16 v[198:199], v225 offset:4608
    s_waitcnt lgkmcnt(7)
    v_mfma_f32_32x32x16_bf16 v[160:175], v[216:219], v[116:119], v[160:175]
    ds_read_b64_tr_b16 v[200:201], v226 offset:4096
    ds_read_b64_tr_b16 v[202:203], v226 offset:4608
    s_waitcnt lgkmcnt(6)
    v_mfma_f32_32x32x16_bf16 v[176:191], v[220:223], v[116:119], v[176:191]
    ds_read_b64_tr_b16 v[204:205], v227 offset:4096
    ds_read_b64_tr_b16 v[206:207], v227 offset:4608
    s_waitcnt lgkmcnt(6)
    v_mfma_f32_32x32x16_bf16 v[128:143], v[192:195], v[120:123], v[128:143]
    ds_read_b64_tr_b16 v[208:209], v224 offset:6144
    ds_read_b64_tr_b16 v[210:211], v224 offset:6656
    s_waitcnt lgkmcnt(6)
    v_mfma_f32_32x32x16_bf16 v[144:159], v[196:199], v[120:123], v[144:159]
    ds_read_b64_tr_b16 v[212:213], v225 offset:6144
    ds_read_b64_tr_b16 v[214:215], v225 offset:6656
    s_waitcnt lgkmcnt(6)
    v_mfma_f32_32x32x16_bf16 v[160:175], v[200:203], v[120:123], v[160:175]
    ds_read_b64_tr_b16 v[216:217], v226 offset:6144
    ds_read_b64_tr_b16 v[218:219], v226 offset:6656
    s_waitcnt lgkmcnt(6)
    v_mfma_f32_32x32x16_bf16 v[176:191], v[204:207], v[120:123], v[176:191]
    ds_read_b64_tr_b16 v[220:221], v227 offset:6144
    ds_read_b64_tr_b16 v[222:223], v227 offset:6656
    v_mfma_f32_32x32x16_bf16 v[128:143], v[240:243], v[232:235], v[128:143]
    v_mfma_f32_32x32x16_bf16 v[144:159], v[244:247], v[232:235], v[144:159]
    v_mfma_f32_32x32x16_bf16 v[160:175], v[248:251], v[232:235], v[160:175]
    v_mfma_f32_32x32x16_bf16 v[176:191], v[252:255], v[232:235], v[176:191]
    v_add_u32 v224, 4294901760, v224
    v_add_u32 v225, 4294901760, v225
    v_add_u32 v226, 4294901760, v226
    v_add_u32 v227, 4294901760, v227
    s_waitcnt lgkmcnt(6)
    v_mfma_f32_32x32x16_bf16 v[128:143], v[208:211], v[124:127], v[128:143]
    ds_read_b64_tr_b16 v[192:193], v224 offset:0
    ds_read_b64_tr_b16 v[194:195], v224 offset:512
    s_waitcnt lgkmcnt(6)
    v_mfma_f32_32x32x16_bf16 v[144:159], v[212:215], v[124:127], v[144:159]
    ds_read_b64_tr_b16 v[196:197], v225 offset:0
    ds_read_b64_tr_b16 v[198:199], v225 offset:512
    s_waitcnt lgkmcnt(6)
    v_mfma_f32_32x32x16_bf16 v[160:175], v[216:219], v[124:127], v[160:175]
    ds_read_b64_tr_b16 v[200:201], v226 offset:0
    ds_read_b64_tr_b16 v[202:203], v226 offset:512
    s_waitcnt lgkmcnt(6)
    v_mfma_f32_32x32x16_bf16 v[176:191], v[220:223], v[124:127], v[176:191]
    s_barrier
    ds_read_b64_tr_b16 v[204:205], v227 offset:0
    ds_read_b64_tr_b16 v[206:207], v227 offset:512
    v_mul_f32 v128, v128, v136
    v_mul_f32 v129, v129, v137
    v_mul_f32 v130, v130, v138
    v_mul_f32 v131, v131, v139
    v_mul_f32 v132, v132, v140
    v_mul_f32 v133, v133, v141
    v_mul_f32 v134, v134, v142
    v_mul_f32 v135, v135, v143
    v_cvt_pk_bf16_f32 v240, v128, v129
    v_cvt_pk_bf16_f32 v241, v130, v131
    v_cvt_pk_bf16_f32 v242, v132, v133
    v_cvt_pk_bf16_f32 v243, v134, v135
    buffer_store_dwordx4 v[240:243], v6, s[68:71], s15 offen offset:0 sc1
    s_waitcnt lgkmcnt(6)
    v_mfma_f32_32x32x16_bf16 v[128:143], v[192:195], v[16:19], 0
    ds_read_b64_tr_b16 v[208:209], v224 offset:2048
    ds_read_b64_tr_b16 v[210:211], v224 offset:2560
    v_mul_f32 v144, v144, v152
    v_mul_f32 v145, v145, v153
    v_mul_f32 v146, v146, v154
    v_mul_f32 v147, v147, v155
    v_mul_f32 v148, v148, v156
    v_mul_f32 v149, v149, v157
    v_mul_f32 v150, v150, v158
    v_mul_f32 v151, v151, v159
    v_cvt_pk_bf16_f32 v244, v144, v145
    v_cvt_pk_bf16_f32 v245, v146, v147
    v_cvt_pk_bf16_f32 v246, v148, v149
    v_cvt_pk_bf16_f32 v247, v150, v151
    buffer_store_dwordx4 v[244:247], v6, s[68:71], s15 offen offset:1024 sc1
    s_waitcnt lgkmcnt(6)
    v_mfma_f32_32x32x16_bf16 v[144:159], v[196:199], v[16:19], 0
    ds_read_b64_tr_b16 v[212:213], v225 offset:2048
    ds_read_b64_tr_b16 v[214:215], v225 offset:2560
    v_mul_f32 v160, v160, v168
    v_mul_f32 v161, v161, v169
    v_mul_f32 v162, v162, v170
    v_mul_f32 v163, v163, v171
    v_mul_f32 v164, v164, v172
    v_mul_f32 v165, v165, v173
    v_mul_f32 v166, v166, v174
    v_mul_f32 v167, v167, v175
    v_cvt_pk_bf16_f32 v248, v160, v161
    v_cvt_pk_bf16_f32 v249, v162, v163
    v_cvt_pk_bf16_f32 v250, v164, v165
    v_cvt_pk_bf16_f32 v251, v166, v167
    buffer_store_dwordx4 v[248:251], v6, s[68:71], s15 offen offset:2048 sc1
    s_waitcnt lgkmcnt(6)
    v_mfma_f32_32x32x16_bf16 v[160:175], v[200:203], v[16:19], 0
    ds_read_b64_tr_b16 v[216:217], v226 offset:2048
    ds_read_b64_tr_b16 v[218:219], v226 offset:2560
    v_mul_f32 v176, v176, v184
    v_mul_f32 v177, v177, v185
    v_mul_f32 v178, v178, v186
    v_mul_f32 v179, v179, v187
    v_mul_f32 v180, v180, v188
    v_mul_f32 v181, v181, v189
    v_mul_f32 v182, v182, v190
    v_mul_f32 v183, v183, v191
    v_cvt_pk_bf16_f32 v252, v176, v177
    v_cvt_pk_bf16_f32 v253, v178, v179
    v_cvt_pk_bf16_f32 v254, v180, v181
    v_cvt_pk_bf16_f32 v255, v182, v183
    buffer_store_dwordx4 v[252:255], v6, s[68:71], s15 offen offset:3072 sc1
    s_waitcnt lgkmcnt(6)
    v_mfma_f32_32x32x16_bf16 v[176:191], v[204:207], v[16:19], 0
    ds_read_b64_tr_b16 v[220:221], v227 offset:2048
    ds_read_b64_tr_b16 v[222:223], v227 offset:2560
    s_waitcnt lgkmcnt(6)
    v_mfma_f32_32x32x16_bf16 v[128:143], v[208:211], v[20:23], v[128:143]
    ds_read_b64_tr_b16 v[192:193], v224 offset:4096
    ds_read_b64_tr_b16 v[194:195], v224 offset:4608
    s_waitcnt lgkmcnt(6)
    v_mfma_f32_32x32x16_bf16 v[144:159], v[212:215], v[20:23], v[144:159]
    ds_read_b64_tr_b16 v[196:197], v225 offset:4096
    ds_read_b64_tr_b16 v[198:199], v225 offset:4608
    s_waitcnt lgkmcnt(6)
    v_mfma_f32_32x32x16_bf16 v[160:175], v[216:219], v[20:23], v[160:175]
    ds_read_b64_tr_b16 v[200:201], v226 offset:4096
    ds_read_b64_tr_b16 v[202:203], v226 offset:4608
    s_waitcnt lgkmcnt(6)
    v_mfma_f32_32x32x16_bf16 v[176:191], v[220:223], v[20:23], v[176:191]
    ds_read_b64_tr_b16 v[204:205], v227 offset:4096
    ds_read_b64_tr_b16 v[206:207], v227 offset:4608
    s_waitcnt lgkmcnt(6)
    v_mfma_f32_32x32x16_bf16 v[128:143], v[192:195], v[24:27], v[128:143]
    ds_read_b64_tr_b16 v[208:209], v224 offset:6144
    ds_read_b64_tr_b16 v[210:211], v224 offset:6656
    s_waitcnt lgkmcnt(6)
    v_mfma_f32_32x32x16_bf16 v[144:159], v[196:199], v[24:27], v[144:159]
    ds_read_b64_tr_b16 v[212:213], v225 offset:6144
    ds_read_b64_tr_b16 v[214:215], v225 offset:6656
    s_waitcnt lgkmcnt(6)
    v_mfma_f32_32x32x16_bf16 v[160:175], v[200:203], v[24:27], v[160:175]
    ds_read_b64_tr_b16 v[216:217], v226 offset:6144
    ds_read_b64_tr_b16 v[218:219], v226 offset:6656
    s_waitcnt lgkmcnt(6)
    v_mfma_f32_32x32x16_bf16 v[176:191], v[204:207], v[24:27], v[176:191]
    ds_read_b64_tr_b16 v[220:221], v227 offset:6144
    ds_read_b64_tr_b16 v[222:223], v227 offset:6656
    v_add_u32 v224, 16384, v224
    v_add_u32 v225, 16384, v225
    v_add_u32 v226, 16384, v226
    v_add_u32 v227, 16384, v227
    s_waitcnt lgkmcnt(6)
    v_mfma_f32_32x32x16_bf16 v[128:143], v[208:211], v[28:31], v[128:143]
    ds_read_b64_tr_b16 v[192:193], v224 offset:0
    ds_read_b64_tr_b16 v[194:195], v224 offset:512
    s_waitcnt lgkmcnt(6)
    v_mfma_f32_32x32x16_bf16 v[144:159], v[212:215], v[28:31], v[144:159]
    ds_read_b64_tr_b16 v[196:197], v225 offset:0
    ds_read_b64_tr_b16 v[198:199], v225 offset:512
    s_waitcnt lgkmcnt(6)
    v_mfma_f32_32x32x16_bf16 v[160:175], v[216:219], v[28:31], v[160:175]
    ds_read_b64_tr_b16 v[200:201], v226 offset:0
    ds_read_b64_tr_b16 v[202:203], v226 offset:512
    s_waitcnt lgkmcnt(6)
    v_mfma_f32_32x32x16_bf16 v[176:191], v[220:223], v[28:31], v[176:191]
    s_barrier
    ds_read_b64_tr_b16 v[204:205], v227 offset:0
    ds_read_b64_tr_b16 v[206:207], v227 offset:512
    s_waitcnt lgkmcnt(6)
    v_mfma_f32_32x32x16_bf16 v[128:143], v[192:195], v[32:35], v[128:143]
    ds_read_b64_tr_b16 v[208:209], v224 offset:2048
    ds_read_b64_tr_b16 v[210:211], v224 offset:2560
    s_waitcnt lgkmcnt(6)
    v_mfma_f32_32x32x16_bf16 v[144:159], v[196:199], v[32:35], v[144:159]
    ds_read_b64_tr_b16 v[212:213], v225 offset:2048
    ds_read_b64_tr_b16 v[214:215], v225 offset:2560
    s_waitcnt lgkmcnt(6)
    v_mfma_f32_32x32x16_bf16 v[160:175], v[200:203], v[32:35], v[160:175]
    ds_read_b64_tr_b16 v[216:217], v226 offset:2048
    ds_read_b64_tr_b16 v[218:219], v226 offset:2560
    s_waitcnt lgkmcnt(6)
    v_mfma_f32_32x32x16_bf16 v[176:191], v[204:207], v[32:35], v[176:191]
    ds_read_b64_tr_b16 v[220:221], v227 offset:2048
    ds_read_b64_tr_b16 v[222:223], v227 offset:2560
    s_waitcnt lgkmcnt(6)
    v_mfma_f32_32x32x16_bf16 v[128:143], v[208:211], v[36:39], v[128:143]
    ds_read_b64_tr_b16 v[192:193], v224 offset:4096
    ds_read_b64_tr_b16 v[194:195], v224 offset:4608
    s_waitcnt lgkmcnt(6)
    v_mfma_f32_32x32x16_bf16 v[144:159], v[212:215], v[36:39], v[144:159]
    ds_read_b64_tr_b16 v[196:197], v225 offset:4096
    ds_read_b64_tr_b16 v[198:199], v225 offset:4608
    s_waitcnt lgkmcnt(6)
    v_mfma_f32_32x32x16_bf16 v[160:175], v[216:219], v[36:39], v[160:175]
    ds_read_b64_tr_b16 v[200:201], v226 offset:4096
    ds_read_b64_tr_b16 v[202:203], v226 offset:4608
    s_waitcnt lgkmcnt(6)
    v_mfma_f32_32x32x16_bf16 v[176:191], v[220:223], v[36:39], v[176:191]
    ds_read_b64_tr_b16 v[204:205], v227 offset:4096
    ds_read_b64_tr_b16 v[206:207], v227 offset:4608
    s_waitcnt lgkmcnt(6)
    v_mfma_f32_32x32x16_bf16 v[128:143], v[192:195], v[40:43], v[128:143]
    ds_read_b64_tr_b16 v[208:209], v224 offset:6144
    ds_read_b64_tr_b16 v[210:211], v224 offset:6656
    s_waitcnt lgkmcnt(6)
    v_mfma_f32_32x32x16_bf16 v[144:159], v[196:199], v[40:43], v[144:159]
    ds_read_b64_tr_b16 v[212:213], v225 offset:6144
    ds_read_b64_tr_b16 v[214:215], v225 offset:6656
    s_waitcnt lgkmcnt(6)
    v_mfma_f32_32x32x16_bf16 v[160:175], v[200:203], v[40:43], v[160:175]
    ds_read_b64_tr_b16 v[216:217], v226 offset:6144
    ds_read_b64_tr_b16 v[218:219], v226 offset:6656
    s_waitcnt lgkmcnt(6)
    v_mfma_f32_32x32x16_bf16 v[176:191], v[204:207], v[40:43], v[176:191]
    ds_read_b64_tr_b16 v[220:221], v227 offset:6144
    ds_read_b64_tr_b16 v[222:223], v227 offset:6656
    v_add_u32 v224, 16384, v224
    v_add_u32 v225, 16384, v225
    v_add_u32 v226, 16384, v226
    v_add_u32 v227, 16384, v227
    s_waitcnt lgkmcnt(6)
    v_mfma_f32_32x32x16_bf16 v[128:143], v[208:211], v[44:47], v[128:143]
    ds_read_b64_tr_b16 v[192:193], v224 offset:0
    ds_read_b64_tr_b16 v[194:195], v224 offset:512
    s_waitcnt lgkmcnt(6)
    v_mfma_f32_32x32x16_bf16 v[144:159], v[212:215], v[44:47], v[144:159]
    ds_read_b64_tr_b16 v[196:197], v225 offset:0
    ds_read_b64_tr_b16 v[198:199], v225 offset:512
    s_waitcnt lgkmcnt(6)
    v_mfma_f32_32x32x16_bf16 v[160:175], v[216:219], v[44:47], v[160:175]
    ds_read_b64_tr_b16 v[200:201], v226 offset:0
    ds_read_b64_tr_b16 v[202:203], v226 offset:512
    s_waitcnt lgkmcnt(6)
    v_mfma_f32_32x32x16_bf16 v[176:191], v[220:223], v[44:47], v[176:191]
    s_barrier
    ds_read_b64_tr_b16 v[204:205], v227 offset:0
    ds_read_b64_tr_b16 v[206:207], v227 offset:512
    s_waitcnt lgkmcnt(6)
    v_mfma_f32_32x32x16_bf16 v[128:143], v[192:195], v[48:51], v[128:143]
    ds_read_b64_tr_b16 v[208:209], v224 offset:2048
    ds_read_b64_tr_b16 v[210:211], v224 offset:2560
    s_waitcnt lgkmcnt(6)
    v_mfma_f32_32x32x16_bf16 v[144:159], v[196:199], v[48:51], v[144:159]
    ds_read_b64_tr_b16 v[212:213], v225 offset:2048
    ds_read_b64_tr_b16 v[214:215], v225 offset:2560
    s_waitcnt lgkmcnt(6)
    v_mfma_f32_32x32x16_bf16 v[160:175], v[200:203], v[48:51], v[160:175]
    ds_read_b64_tr_b16 v[216:217], v226 offset:2048
    ds_read_b64_tr_b16 v[218:219], v226 offset:2560
    s_waitcnt lgkmcnt(6)
    v_mfma_f32_32x32x16_bf16 v[176:191], v[204:207], v[48:51], v[176:191]
    ds_read_b64_tr_b16 v[220:221], v227 offset:2048
    ds_read_b64_tr_b16 v[222:223], v227 offset:2560
    s_add_u32 s15, s15, 3670016
    s_waitcnt lgkmcnt(6)
    v_mfma_f32_32x32x16_bf16 v[128:143], v[208:211], v[52:55], v[128:143]
    ds_read_b64_tr_b16 v[192:193], v224 offset:4096
    ds_read_b64_tr_b16 v[194:195], v224 offset:4608
    s_waitcnt lgkmcnt(6)
    v_mfma_f32_32x32x16_bf16 v[144:159], v[212:215], v[52:55], v[144:159]
    ds_read_b64_tr_b16 v[196:197], v225 offset:4096
    ds_read_b64_tr_b16 v[198:199], v225 offset:4608
    s_waitcnt lgkmcnt(6)
    v_mfma_f32_32x32x16_bf16 v[160:175], v[216:219], v[52:55], v[160:175]
    ds_read_b64_tr_b16 v[200:201], v226 offset:4096
    ds_read_b64_tr_b16 v[202:203], v226 offset:4608
    s_waitcnt lgkmcnt(6)
    v_mfma_f32_32x32x16_bf16 v[176:191], v[220:223], v[52:55], v[176:191]
    ds_read_b64_tr_b16 v[204:205], v227 offset:4096
    ds_read_b64_tr_b16 v[206:207], v227 offset:4608
    s_waitcnt lgkmcnt(6)
    v_mfma_f32_32x32x16_bf16 v[128:143], v[192:195], v[56:59], v[128:143]
    ds_read_b64_tr_b16 v[208:209], v224 offset:6144
    ds_read_b64_tr_b16 v[210:211], v224 offset:6656
    s_waitcnt lgkmcnt(6)
    v_mfma_f32_32x32x16_bf16 v[144:159], v[196:199], v[56:59], v[144:159]
    ds_read_b64_tr_b16 v[212:213], v225 offset:6144
    ds_read_b64_tr_b16 v[214:215], v225 offset:6656
    s_waitcnt lgkmcnt(6)
    v_mfma_f32_32x32x16_bf16 v[160:175], v[200:203], v[56:59], v[160:175]
    ds_read_b64_tr_b16 v[216:217], v226 offset:6144
    ds_read_b64_tr_b16 v[218:219], v226 offset:6656
    s_waitcnt lgkmcnt(6)
    v_mfma_f32_32x32x16_bf16 v[176:191], v[204:207], v[56:59], v[176:191]
    ds_read_b64_tr_b16 v[220:221], v227 offset:6144
    ds_read_b64_tr_b16 v[222:223], v227 offset:6656
    v_add_u32 v224, 65536, v224
    v_add_u32 v225, 65536, v225
    v_add_u32 v226, 65536, v226
    v_add_u32 v227, 65536, v227
    s_waitcnt lgkmcnt(6)
    v_mfma_f32_32x32x16_bf16 v[128:143], v[208:211], v[60:63], v[128:143]
    ds_read_b64_tr_b16 v[192:193], v224 offset:0
    ds_read_b64_tr_b16 v[194:195], v224 offset:512
    s_waitcnt lgkmcnt(6)
    v_mfma_f32_32x32x16_bf16 v[144:159], v[212:215], v[60:63], v[144:159]
    ds_read_b64_tr_b16 v[196:197], v225 offset:0
    ds_read_b64_tr_b16 v[198:199], v225 offset:512
    s_waitcnt lgkmcnt(6)
    v_mfma_f32_32x32x16_bf16 v[160:175], v[216:219], v[60:63], v[160:175]
    ds_read_b64_tr_b16 v[200:201], v226 offset:0
    ds_read_b64_tr_b16 v[202:203], v226 offset:512
    s_waitcnt lgkmcnt(6)
    v_mfma_f32_32x32x16_bf16 v[176:191], v[220:223], v[60:63], v[176:191]
    s_barrier
    ds_read_b64_tr_b16 v[204:205], v227 offset:0
    ds_read_b64_tr_b16 v[206:207], v227 offset:512
    s_waitcnt lgkmcnt(6)
    v_mfma_f32_32x32x16_bf16 v[128:143], v[192:195], v[64:67], v[128:143]
    ds_read_b64_tr_b16 v[208:209], v224 offset:2048
    ds_read_b64_tr_b16 v[210:211], v224 offset:2560
    s_waitcnt lgkmcnt(6)
    v_mfma_f32_32x32x16_bf16 v[144:159], v[196:199], v[64:67], v[144:159]
    ds_read_b64_tr_b16 v[212:213], v225 offset:2048
    ds_read_b64_tr_b16 v[214:215], v225 offset:2560
    s_waitcnt lgkmcnt(6)
    v_mfma_f32_32x32x16_bf16 v[160:175], v[200:203], v[64:67], v[160:175]
    ds_read_b64_tr_b16 v[216:217], v226 offset:2048
    ds_read_b64_tr_b16 v[218:219], v226 offset:2560
    s_waitcnt lgkmcnt(6)
    v_mfma_f32_32x32x16_bf16 v[176:191], v[204:207], v[64:67], v[176:191]
    ds_read_b64_tr_b16 v[220:221], v227 offset:2048
    ds_read_b64_tr_b16 v[222:223], v227 offset:2560
    s_waitcnt vmcnt(0)
    s_add_u32 s93, s87, 524288
    v_mov_b32 v228, s11
    s_mov_b64 exec, 1
    buffer_store_dword v228, off, s[68:71], s93 sc1
    s_mov_b64 exec, -1
    s_waitcnt lgkmcnt(6)
    v_mfma_f32_32x32x16_bf16 v[128:143], v[208:211], v[68:71], v[128:143]
    ds_read_b64_tr_b16 v[192:193], v224 offset:4096
    ds_read_b64_tr_b16 v[194:195], v224 offset:4608
    s_waitcnt lgkmcnt(6)
    v_mfma_f32_32x32x16_bf16 v[144:159], v[212:215], v[68:71], v[144:159]
    ds_read_b64_tr_b16 v[196:197], v225 offset:4096
    ds_read_b64_tr_b16 v[198:199], v225 offset:4608
    s_waitcnt lgkmcnt(6)
    v_mfma_f32_32x32x16_bf16 v[160:175], v[216:219], v[68:71], v[160:175]
    ds_read_b64_tr_b16 v[200:201], v226 offset:4096
    ds_read_b64_tr_b16 v[202:203], v226 offset:4608
    s_waitcnt lgkmcnt(6)
    v_mfma_f32_32x32x16_bf16 v[176:191], v[220:223], v[68:71], v[176:191]
    ds_read_b64_tr_b16 v[204:205], v227 offset:4096
    ds_read_b64_tr_b16 v[206:207], v227 offset:4608
    s_waitcnt lgkmcnt(6)
    v_mfma_f32_32x32x16_bf16 v[128:143], v[192:195], v[72:75], v[128:143]
    ds_read_b64_tr_b16 v[208:209], v224 offset:6144
    ds_read_b64_tr_b16 v[210:211], v224 offset:6656
    s_waitcnt lgkmcnt(6)
    v_mfma_f32_32x32x16_bf16 v[144:159], v[196:199], v[72:75], v[144:159]
    ds_read_b64_tr_b16 v[212:213], v225 offset:6144
    ds_read_b64_tr_b16 v[214:215], v225 offset:6656
    s_waitcnt lgkmcnt(6)
    v_mfma_f32_32x32x16_bf16 v[160:175], v[200:203], v[72:75], v[160:175]
    ds_read_b64_tr_b16 v[216:217], v226 offset:6144
    ds_read_b64_tr_b16 v[218:219], v226 offset:6656
    s_waitcnt lgkmcnt(6)
    v_mfma_f32_32x32x16_bf16 v[176:191], v[204:207], v[72:75], v[176:191]
    ds_read_b64_tr_b16 v[220:221], v227 offset:6144
    ds_read_b64_tr_b16 v[222:223], v227 offset:6656
    v_add_u32 v224, 4294918144, v224
    v_add_u32 v225, 4294918144, v225
    v_add_u32 v226, 4294918144, v226
    v_add_u32 v227, 4294918144, v227
    s_waitcnt lgkmcnt(6)
    v_mfma_f32_32x32x16_bf16 v[128:143], v[208:211], v[76:79], v[128:143]
    ds_read_b64_tr_b16 v[192:193], v224 offset:0
    ds_read_b64_tr_b16 v[194:195], v224 offset:512
    s_waitcnt lgkmcnt(6)
    v_mfma_f32_32x32x16_bf16 v[144:159], v[212:215], v[76:79], v[144:159]
    ds_read_b64_tr_b16 v[196:197], v225 offset:0
    ds_read_b64_tr_b16 v[198:199], v225 offset:512
    s_waitcnt lgkmcnt(6)
    v_mfma_f32_32x32x16_bf16 v[160:175], v[216:219], v[76:79], v[160:175]
    ds_read_b64_tr_b16 v[200:201], v226 offset:0
    ds_read_b64_tr_b16 v[202:203], v226 offset:512
    s_waitcnt lgkmcnt(6)
    v_mfma_f32_32x32x16_bf16 v[176:191], v[220:223], v[76:79], v[176:191]
    s_barrier
    ds_read_b64_tr_b16 v[204:205], v227 offset:0
    ds_read_b64_tr_b16 v[206:207], v227 offset:512
    s_waitcnt lgkmcnt(6)
    v_mfma_f32_32x32x16_bf16 v[128:143], v[192:195], v[80:83], v[128:143]
    ds_read_b64_tr_b16 v[208:209], v224 offset:2048
    ds_read_b64_tr_b16 v[210:211], v224 offset:2560
    s_waitcnt lgkmcnt(6)
    v_mfma_f32_32x32x16_bf16 v[144:159], v[196:199], v[80:83], v[144:159]
    ds_read_b64_tr_b16 v[212:213], v225 offset:2048
    ds_read_b64_tr_b16 v[214:215], v225 offset:2560
    s_waitcnt lgkmcnt(6)
    v_mfma_f32_32x32x16_bf16 v[160:175], v[200:203], v[80:83], v[160:175]
    ds_read_b64_tr_b16 v[216:217], v226 offset:2048
    ds_read_b64_tr_b16 v[218:219], v226 offset:2560
    s_waitcnt lgkmcnt(6)
    v_mfma_f32_32x32x16_bf16 v[176:191], v[204:207], v[80:83], v[176:191]
    ds_read_b64_tr_b16 v[220:221], v227 offset:2048
    ds_read_b64_tr_b16 v[222:223], v227 offset:2560
    s_waitcnt lgkmcnt(6)
    v_mfma_f32_32x32x16_bf16 v[128:143], v[208:211], v[84:87], v[128:143]
    ds_read_b64_tr_b16 v[192:193], v224 offset:4096
    ds_read_b64_tr_b16 v[194:195], v224 offset:4608
    s_waitcnt lgkmcnt(6)
    v_mfma_f32_32x32x16_bf16 v[144:159], v[212:215], v[84:87], v[144:159]
    ds_read_b64_tr_b16 v[196:197], v225 offset:4096
    ds_read_b64_tr_b16 v[198:199], v225 offset:4608
    s_waitcnt lgkmcnt(6)
    v_mfma_f32_32x32x16_bf16 v[160:175], v[216:219], v[84:87], v[160:175]
    ds_read_b64_tr_b16 v[200:201], v226 offset:4096
    ds_read_b64_tr_b16 v[202:203], v226 offset:4608
    s_waitcnt lgkmcnt(6)
    v_mfma_f32_32x32x16_bf16 v[176:191], v[220:223], v[84:87], v[176:191]
    ds_read_b64_tr_b16 v[204:205], v227 offset:4096
    ds_read_b64_tr_b16 v[206:207], v227 offset:4608
    s_waitcnt lgkmcnt(6)
    v_mfma_f32_32x32x16_bf16 v[128:143], v[192:195], v[88:91], v[128:143]
    ds_read_b64_tr_b16 v[208:209], v224 offset:6144
    ds_read_b64_tr_b16 v[210:211], v224 offset:6656
    s_waitcnt lgkmcnt(6)
    v_mfma_f32_32x32x16_bf16 v[144:159], v[196:199], v[88:91], v[144:159]
    ds_read_b64_tr_b16 v[212:213], v225 offset:6144
    ds_read_b64_tr_b16 v[214:215], v225 offset:6656
    s_waitcnt lgkmcnt(6)
    v_mfma_f32_32x32x16_bf16 v[160:175], v[200:203], v[88:91], v[160:175]
    ds_read_b64_tr_b16 v[216:217], v226 offset:6144
    ds_read_b64_tr_b16 v[218:219], v226 offset:6656
    s_waitcnt lgkmcnt(6)
    v_mfma_f32_32x32x16_bf16 v[176:191], v[204:207], v[88:91], v[176:191]
    ds_read_b64_tr_b16 v[220:221], v227 offset:6144
    ds_read_b64_tr_b16 v[222:223], v227 offset:6656
    v_add_u32 v224, 16384, v224
    v_add_u32 v225, 16384, v225
    v_add_u32 v226, 16384, v226
    v_add_u32 v227, 16384, v227
    s_waitcnt lgkmcnt(6)
    v_mfma_f32_32x32x16_bf16 v[128:143], v[208:211], v[92:95], v[128:143]
    ds_read_b64_tr_b16 v[192:193], v224 offset:0
    ds_read_b64_tr_b16 v[194:195], v224 offset:512
    s_waitcnt lgkmcnt(6)
    v_mfma_f32_32x32x16_bf16 v[144:159], v[212:215], v[92:95], v[144:159]
    ds_read_b64_tr_b16 v[196:197], v225 offset:0
    ds_read_b64_tr_b16 v[198:199], v225 offset:512
    s_waitcnt lgkmcnt(6)
    v_mfma_f32_32x32x16_bf16 v[160:175], v[216:219], v[92:95], v[160:175]
    ds_read_b64_tr_b16 v[200:201], v226 offset:0
    ds_read_b64_tr_b16 v[202:203], v226 offset:512
    s_waitcnt lgkmcnt(6)
    v_mfma_f32_32x32x16_bf16 v[176:191], v[220:223], v[92:95], v[176:191]
    s_barrier
    ds_read_b64_tr_b16 v[204:205], v227 offset:0
    ds_read_b64_tr_b16 v[206:207], v227 offset:512
    s_waitcnt lgkmcnt(6)
    v_mfma_f32_32x32x16_bf16 v[128:143], v[192:195], v[96:99], v[128:143]
    ds_read_b64_tr_b16 v[208:209], v224 offset:2048
    ds_read_b64_tr_b16 v[210:211], v224 offset:2560
    s_waitcnt lgkmcnt(6)
    v_mfma_f32_32x32x16_bf16 v[144:159], v[196:199], v[96:99], v[144:159]
    ds_read_b64_tr_b16 v[212:213], v225 offset:2048
    ds_read_b64_tr_b16 v[214:215], v225 offset:2560
    s_waitcnt lgkmcnt(6)
    v_mfma_f32_32x32x16_bf16 v[160:175], v[200:203], v[96:99], v[160:175]
    ds_read_b64_tr_b16 v[216:217], v226 offset:2048
    ds_read_b64_tr_b16 v[218:219], v226 offset:2560
    s_waitcnt lgkmcnt(6)
    v_mfma_f32_32x32x16_bf16 v[176:191], v[204:207], v[96:99], v[176:191]
    ds_read_b64_tr_b16 v[220:221], v227 offset:2048
    ds_read_b64_tr_b16 v[222:223], v227 offset:2560
    s_waitcnt lgkmcnt(6)
    v_mfma_f32_32x32x16_bf16 v[128:143], v[208:211], v[100:103], v[128:143]
    ds_read_b64_tr_b16 v[192:193], v224 offset:4096
    ds_read_b64_tr_b16 v[194:195], v224 offset:4608
    s_waitcnt lgkmcnt(6)
    v_mfma_f32_32x32x16_bf16 v[144:159], v[212:215], v[100:103], v[144:159]
    ds_read_b64_tr_b16 v[196:197], v225 offset:4096
    ds_read_b64_tr_b16 v[198:199], v225 offset:4608
    s_waitcnt lgkmcnt(6)
    v_mfma_f32_32x32x16_bf16 v[160:175], v[216:219], v[100:103], v[160:175]
    ds_read_b64_tr_b16 v[200:201], v226 offset:4096
    ds_read_b64_tr_b16 v[202:203], v226 offset:4608
    s_waitcnt lgkmcnt(6)
    v_mfma_f32_32x32x16_bf16 v[176:191], v[220:223], v[100:103], v[176:191]
    ds_read_b64_tr_b16 v[204:205], v227 offset:4096
    ds_read_b64_tr_b16 v[206:207], v227 offset:4608
    s_waitcnt lgkmcnt(6)
    v_mfma_f32_32x32x16_bf16 v[128:143], v[192:195], v[104:107], v[128:143]
    ds_read_b64_tr_b16 v[208:209], v224 offset:6144
    ds_read_b64_tr_b16 v[210:211], v224 offset:6656
    s_waitcnt lgkmcnt(6)
    v_mfma_f32_32x32x16_bf16 v[144:159], v[196:199], v[104:107], v[144:159]
    ds_read_b64_tr_b16 v[212:213], v225 offset:6144
    ds_read_b64_tr_b16 v[214:215], v225 offset:6656
    s_waitcnt lgkmcnt(6)
    v_mfma_f32_32x32x16_bf16 v[160:175], v[200:203], v[104:107], v[160:175]
    ds_read_b64_tr_b16 v[216:217], v226 offset:6144
    ds_read_b64_tr_b16 v[218:219], v226 offset:6656
    s_waitcnt lgkmcnt(6)
    v_mfma_f32_32x32x16_bf16 v[176:191], v[204:207], v[104:107], v[176:191]
    ds_read_b64_tr_b16 v[220:221], v227 offset:6144
    ds_read_b64_tr_b16 v[222:223], v227 offset:6656
    buffer_load_dword v8, v7, s[68:71], s91 offen sc1
    v_add_u32 v224, 4294901760, v224
    v_add_u32 v225, 4294901760, v225
    v_add_u32 v226, 4294901760, v226
    v_add_u32 v227, 4294901760, v227
    s_waitcnt lgkmcnt(6)
    v_mfma_f32_32x32x16_bf16 v[128:143], v[208:211], v[108:111], v[128:143]
    ds_read_b64_tr_b16 v[192:193], v224 offset:0
    ds_read_b64_tr_b16 v[194:195], v224 offset:512
    v_mov_b32 v241, 0
    v_mov_b32 v242, 0
    v_mov_b32 v243, 0
    s_waitcnt lgkmcnt(6)
    v_mfma_f32_32x32x16_bf16 v[144:159], v[212:215], v[108:111], v[144:159]
    ds_read_b64_tr_b16 v[196:197], v225 offset:0
    ds_read_b64_tr_b16 v[198:199], v225 offset:512
    v_mov_b32 v245, 0
    v_mov_b32 v246, 0
    v_mov_b32 v247, 0
    s_waitcnt lgkmcnt(6)
    v_mfma_f32_32x32x16_bf16 v[160:175], v[216:219], v[108:111], v[160:175]
    ds_read_b64_tr_b16 v[200:201], v226 offset:0
    ds_read_b64_tr_b16 v[202:203], v226 offset:512
    v_mov_b32 v249, 0
    v_mov_b32 v250, 0
    v_mov_b32 v251, 0
    s_waitcnt lgkmcnt(6)
    v_mfma_f32_32x32x16_bf16 v[176:191], v[220:223], v[108:111], v[176:191]
    s_barrier
    ds_read_b64_tr_b16 v[204:205], v227 offset:0
    ds_read_b64_tr_b16 v[206:207], v227 offset:512
    v_mov_b32 v253, 0
    v_mov_b32 v254, 0
    v_mov_b32 v255, 0
    s_waitcnt lgkmcnt(6)
    v_mfma_f32_32x32x16_bf16 v[128:143], v[192:195], v[112:115], v[128:143]
    ds_read_b32 v240, v236 offset:256
    ds_read_b64_tr_b16 v[208:209], v224 offset:2048
    ds_read_b64_tr_b16 v[210:211], v224 offset:2560
    s_waitcnt lgkmcnt(7)
    v_mfma_f32_32x32x16_bf16 v[144:159], v[196:199], v[112:115], v[144:159]
    ds_read_b32 v244, v236 offset:320
    ds_read_b64_tr_b16 v[212:213], v225 offset:2048
    ds_read_b64_tr_b16 v[214:215], v225 offset:2560
    s_waitcnt lgkmcnt(8)
    v_mfma_f32_32x32x16_bf16 v[160:175], v[200:203], v[112:115], v[160:175]
    ds_read_b32 v248, v236 offset:384
    ds_read_b64_tr_b16 v[216:217], v226 offset:2048
    ds_read_b64_tr_b16 v[218:219], v226 offset:2560
    s_waitcnt lgkmcnt(9)
    v_mfma_f32_32x32x16_bf16 v[176:191], v[204:207], v[112:115], v[176:191]
    ds_read_b32 v252, v236 offset:448
    ds_read_b64_tr_b16 v[220:221], v227 offset:2048
    ds_read_b64_tr_b16 v[222:223], v227 offset:2560
    s_waitcnt lgkmcnt(9)
    v_mfma_f32_32x32x16_bf16 v[128:143], v[208:211], v[116:119], v[128:143]
    ds_read_b64_tr_b16 v[192:193], v224 offset:4096
    ds_read_b64_tr_b16 v[194:195], v224 offset:4608
    s_waitcnt lgkmcnt(8)
    v_mfma_f32_32x32x16_bf16 v[144:159], v[212:215], v[116:119], v[144:159]
    ds_read_b64_tr_b16 v[196:197], v225 offset:4096
    ds_read_b64_tr_b16 v[198:199], v225 offset:4608
    s_waitcnt lgkmcnt(7)
    v_mfma_f32_32x32x16_bf16 v[160:175], v[216:219], v[116:119], v[160:175]
    ds_read_b64_tr_b16 v[200:201], v226 offset:4096
    ds_read_b64_tr_b16 v[202:203], v226 offset:4608
    s_waitcnt lgkmcnt(6)
    v_mfma_f32_32x32x16_bf16 v[176:191], v[220:223], v[116:119], v[176:191]
    ds_read_b64_tr_b16 v[204:205], v227 offset:4096
    ds_read_b64_tr_b16 v[206:207], v227 offset:4608
    s_waitcnt vmcnt(0)
    v_cmp_ne_u32 vcc, s11, v8
    s_cbranch_vccnz L_gfa_slow
L_gfa_ok:
    s_waitcnt lgkmcnt(6)
    v_mfma_f32_32x32x16_bf16 v[128:143], v[192:195], v[120:123], v[128:143]
    ds_read_b64_tr_b16 v[208:209], v224 offset:6144
    ds_read_b64_tr_b16 v[210:211], v224 offset:6656
    s_add_u32 s12, s90, 0
    buffer_load_dwordx4 v[16:19], v6, s[68:71], s12 offen offset:0 sc1
    buffer_load_dwordx4 v[20:23], v6, s[68:71], s12 offen offset:1024 sc1
    s_waitcnt lgkmcnt(6)
    v_mfma_f32_32x32x16_bf16 v[144:159], v[196:199], v[120:123], v[144:159]
    ds_read_b64_tr_b16 v[212:213], v225 offset:6144
    ds_read_b64_tr_b16 v[214:215], v225 offset:6656
    buffer_load_dwordx4 v[24:27], v6, s[68:71], s12 offen offset:2048 sc1
    buffer_load_dwordx4 v[28:31], v6, s[68:71], s12 offen offset:3072 sc1
    s_waitcnt lgkmcnt(6)
    v_mfma_f32_32x32x16_bf16 v[160:175], v[200:203], v[120:123], v[160:175]
    ds_read_b64_tr_b16 v[216:217], v226 offset:6144
    ds_read_b64_tr_b16 v[218:219], v226 offset:6656
    s_add_u32 s12, s90, 4096
    buffer_load_dwordx4 v[32:35], v6, s[68:71], s12 offen offset:0 sc1
    buffer_load_dwordx4 v[36:39], v6, s[68:71], s12 offen offset:1024 sc1
    s_waitcnt lgkmcnt(6)
    v_mfma_f32_32x32x16_bf16 v[176:191], v[204:207], v[120:123], v[176:191]
    ds_read_b64_tr_b16 v[220:221], v227 offset:6144
    ds_read_b64_tr_b16 v[222:223], v227 offset:6656
    buffer_load_dwordx4 v[40:43], v6, s[68:71], s12 offen offset:2048 sc1
    buffer_load_dwordx4 v[44:47], v6, s[68:71], s12 offen offset:3072 sc1
    v_mfma_f32_32x32x16_bf16 v[128:143], v[240:243], v[232:235], v[128:143]
    s_add_u32 s12, s90, 8192
    buffer_load_dwordx4 v[48:51], v6, s[68:71], s12 offen offset:0 sc1
    buffer_load_dwordx4 v[52:55], v6, s[68:71], s12 offen offset:1024 sc1
    v_mfma_f32_32x32x16_bf16 v[144:159], v[244:247], v[232:235], v[144:159]
    buffer_load_dwordx4 v[56:59], v6, s[68:71], s12 offen offset:2048 sc1
    buffer_load_dwordx4 v[60:63], v6, s[68:71], s12 offen offset:3072 sc1
    v_mfma_f32_32x32x16_bf16 v[160:175], v[248:251], v[232:235], v[160:175]
    s_add_u32 s12, s90, 12288
    buffer_load_dwordx4 v[64:67], v6, s[68:71], s12 offen offset:0 sc1
    buffer_load_dwordx4 v[68:71], v6, s[68:71], s12 offen offset:1024 sc1
    v_mfma_f32_32x32x16_bf16 v[176:191], v[252:255], v[232:235], v[176:191]
    buffer_load_dwordx4 v[72:75], v6, s[68:71], s12 offen offset:2048 sc1
    buffer_load_dwordx4 v[76:79], v6, s[68:71], s12 offen offset:3072 sc1
    s_waitcnt lgkmcnt(6)
    v_mfma_f32_32x32x16_bf16 v[128:143], v[208:211], v[124:127], v[128:143]
    s_add_u32 s12, s90, 16384
    buffer_load_dwordx4 v[80:83], v6, s[68:71], s12 offen offset:0 sc1
    buffer_load_dwordx4 v[84:87], v6, s[68:71], s12 offen offset:1024 sc1
    s_waitcnt lgkmcnt(4)
    v_mfma_f32_32x32x16_bf16 v[144:159], v[212:215], v[124:127], v[144:159]
    buffer_load_dwordx4 v[88:91], v6, s[68:71], s12 offen offset:2048 sc1
    buffer_load_dwordx4 v[92:95], v6, s[68:71], s12 offen offset:3072 sc1
    s_waitcnt lgkmcnt(2)
    v_mfma_f32_32x32x16_bf16 v[160:175], v[216:219], v[124:127], v[160:175]
    s_waitcnt lgkmcnt(0)
    v_mfma_f32_32x32x16_bf16 v[176:191], v[220:223], v[124:127], v[176:191]
    s_barrier
    s_setprio 3
    v_mul_f32 v128, v128, v136
    v_mul_f32 v129, v129, v137
    v_mul_f32 v130, v130, v138
    v_mul_f32 v131, v131, v139
    v_mul_f32 v132, v132, v140
    v_mul_f32 v133, v133, v141
    v_mul_f32 v134, v134, v142
    v_mul_f32 v135, v135, v143
    v_cvt_pk_bf16_f32 v240, v128, v129
    v_cvt_pk_bf16_f32 v241, v130, v131
    v_cvt_pk_bf16_f32 v242, v132, v133
    v_cvt_pk_bf16_f32 v243, v134, v135
    buffer_store_dwordx4 v[240:243], v6, s[68:71], s15 offen offset:0 sc1
    v_mul_f32 v144, v144, v152
    v_mul_f32 v145, v145, v153
    v_mul_f32 v146, v146, v154
    v_mul_f32 v147, v147, v155
    v_mul_f32 v148, v148, v156
    v_mul_f32 v149, v149, v157
    v_mul_f32 v150, v150, v158
    v_mul_f32 v151, v151, v159
    v_cvt_pk_bf16_f32 v244, v144, v145
    v_cvt_pk_bf16_f32 v245, v146, v147
    v_cvt_pk_bf16_f32 v246, v148, v149
    v_cvt_pk_bf16_f32 v247, v150, v151
    v_mul_f32 v160, v160, v168
    v_mul_f32 v161, v161, v169
    v_mul_f32 v162, v162, v170
    v_mul_f32 v163, v163, v171
    v_mul_f32 v164, v164, v172
    v_mul_f32 v165, v165, v173
    v_mul_f32 v166, v166, v174
    v_mul_f32 v167, v167, v175
    v_cvt_pk_bf16_f32 v248, v160, v161
    v_cvt_pk_bf16_f32 v249, v162, v163
    v_cvt_pk_bf16_f32 v250, v164, v165
    v_cvt_pk_bf16_f32 v251, v166, v167
    v_mul_f32 v176, v176, v184
    v_mul_f32 v177, v177, v185
    v_mul_f32 v178, v178, v186
    v_mul_f32 v179, v179, v187
    v_mul_f32 v180, v180, v188
    v_mul_f32 v181, v181, v189
    v_mul_f32 v182, v182, v190
    v_mul_f32 v183, v183, v191
    v_cvt_pk_bf16_f32 v252, v176, v177
    v_cvt_pk_bf16_f32 v253, v178, v179
    v_cvt_pk_bf16_f32 v254, v180, v181
    v_cvt_pk_bf16_f32 v255, v182, v183
    ds_read_b64_tr_b16 v[160:161], v9 offset:0
    ds_read_b64_tr_b16 v[162:163], v9 offset:512
    ds_read_b64_tr_b16 v[164:165], v10 offset:0
    ds_read_b64_tr_b16 v[166:167], v10 offset:512
    s_waitcnt vmcnt(20)
    s_waitcnt lgkmcnt(2)
    v_mfma_f32_32x32x16_bf16 v[128:143], v[160:163], v[16:19], 0
    ds_read_b64_tr_b16 v[168:169], v9 offset:2048
    ds_read_b64_tr_b16 v[170:171], v9 offset:2560
    buffer_store_dwordx4 v[244:247], v6, s[68:71], s15 offen offset:1024 sc1
    s_waitcnt lgkmcnt(2)
    v_mfma_f32_32x32x16_bf16 v[144:159], v[164:167], v[16:19], 0
    ds_read_b64_tr_b16 v[172:173], v10 offset:2048
    ds_read_b64_tr_b16 v[174:175], v10 offset:2560
    s_waitcnt vmcnt(20)
    s_waitcnt lgkmcnt(2)
    v_mfma_f32_32x32x16_bf16 v[128:143], v[168:171], v[20:23], v[128:143]
    ds_read_b64_tr_b16 v[160:161], v9 offset:4096
    ds_read_b64_tr_b16 v[162:163], v9 offset:4608
    buffer_store_dwordx4 v[248:251], v6, s[68:71], s15 offen offset:2048 sc1
    s_waitcnt lgkmcnt(2)
    v_mfma_f32_32x32x16_bf16 v[144:159], v[172:175], v[20:23], v[144:159]
    ds_read_b64_tr_b16 v[164:165], v10 offset:4096
    ds_read_b64_tr_b16 v[166:167], v10 offset:4608
    s_waitcnt vmcnt(20)
    s_waitcnt lgkmcnt(2)
    v_mfma_f32_32x32x16_bf16 v[128:143], v[160:163], v[24:27], v[128:143]
    ds_read_b64_tr_b16 v[168:169], v9 offset:6144
    ds_read_b64_tr_b16 v[170:171], v9 offset:6656
    buffer_store_dwordx4 v[252:255], v6, s[68:71], s15 offen offset:3072 sc1
    s_setprio 2
    s_waitcnt lgkmcnt(2)
    v_mfma_f32_32x32x16_bf16 v[144:159], v[164:167], v[24:27], v[144:159]
    ds_read_b64_tr_b16 v[172:173], v10 offset:6144
    ds_read_b64_tr_b16 v[174:175], v10 offset:6656
    v_add_u32 v9, 4294901760, v9
    v_add_u32 v10, 4294901760, v10
    s_waitcnt vmcnt(20)
    s_waitcnt lgkmcnt(2)
    v_mfma_f32_32x32x16_bf16 v[128:143], v[168:171], v[28:31], v[128:143]
    ds_read_b64_tr_b16 v[160:161], v9 offset:0
    ds_read_b64_tr_b16 v[162:163], v9 offset:512
    s_waitcnt lgkmcnt(2)
    v_mfma_f32_32x32x16_bf16 v[144:159], v[172:175], v[28:31], v[144:159]
    ds_read_b64_tr_b16 v[164:165], v10 offset:0
    ds_read_b64_tr_b16 v[166:167], v10 offset:512
    s_waitcnt vmcnt(19)
    s_waitcnt lgkmcnt(2)
    v_mfma_f32_32x32x16_bf16 v[128:143], v[160:163], v[32:35], v[128:143]
    ds_read_b64_tr_b16 v[168:169], v9 offset:2048
    ds_read_b64_tr_b16 v[170:171], v9 offset:2560
    s_waitcnt lgkmcnt(2)
    v_mfma_f32_32x32x16_bf16 v[144:159], v[164:167], v[32:35], v[144:159]
    ds_read_b64_tr_b16 v[172:173], v10 offset:2048
    ds_read_b64_tr_b16 v[174:175], v10 offset:2560
    s_waitcnt vmcnt(18)
    s_waitcnt lgkmcnt(2)
    v_mfma_f32_32x32x16_bf16 v[128:143], v[168:171], v[36:39], v[128:143]
    ds_read_b64_tr_b16 v[160:161], v9 offset:4096
    ds_read_b64_tr_b16 v[162:163], v9 offset:4608
    s_waitcnt lgkmcnt(2)
    v_mfma_f32_32x32x16_bf16 v[144:159], v[172:175], v[36:39], v[144:159]
    ds_read_b64_tr_b16 v[164:165], v10 offset:4096
    ds_read_b64_tr_b16 v[166:167], v10 offset:4608
    s_waitcnt vmcnt(17)
    s_waitcnt lgkmcnt(2)
    v_mfma_f32_32x32x16_bf16 v[128:143], v[160:163], v[40:43], v[128:143]
    ds_read_b64_tr_b16 v[168:169], v9 offset:6144
    ds_read_b64_tr_b16 v[170:171], v9 offset:6656
    s_waitcnt lgkmcnt(2)
    v_mfma_f32_32x32x16_bf16 v[144:159], v[164:167], v[40:43], v[144:159]
    ds_read_b64_tr_b16 v[172:173], v10 offset:6144
    ds_read_b64_tr_b16 v[174:175], v10 offset:6656
    v_add_u32 v9, 4294934528, v9
    v_add_u32 v10, 4294934528, v10
    s_waitcnt vmcnt(16)
    s_waitcnt lgkmcnt(2)
    v_mfma_f32_32x32x16_bf16 v[128:143], v[168:171], v[44:47], v[128:143]
    ds_read_b64_tr_b16 v[160:161], v9 offset:0
    ds_read_b64_tr_b16 v[162:163], v9 offset:512
    s_waitcnt lgkmcnt(2)
    v_mfma_f32_32x32x16_bf16 v[144:159], v[172:175], v[44:47], v[144:159]
    ds_read_b64_tr_b16 v[164:165], v10 offset:0
    ds_read_b64_tr_b16 v[166:167], v10 offset:512
    s_waitcnt vmcnt(15)
    s_waitcnt lgkmcnt(2)
    v_mfma_f32_32x32x16_bf16 v[128:143], v[160:163], v[48:51], v[128:143]
    ds_read_b64_tr_b16 v[168:169], v9 offset:2048
    ds_read_b64_tr_b16 v[170:171], v9 offset:2560
    s_waitcnt lgkmcnt(2)
    v_mfma_f32_32x32x16_bf16 v[144:159], v[164:167], v[48:51], v[144:159]
    ds_read_b64_tr_b16 v[172:173], v10 offset:2048
    ds_read_b64_tr_b16 v[174:175], v10 offset:2560
    s_waitcnt vmcnt(14)
    s_waitcnt lgkmcnt(2)
    v_mfma_f32_32x32x16_bf16 v[128:143], v[168:171], v[52:55], v[128:143]
    ds_read_b64_tr_b16 v[160:161], v9 offset:4096
    ds_read_b64_tr_b16 v[162:163], v9 offset:4608
    s_waitcnt lgkmcnt(2)
    v_mfma_f32_32x32x16_bf16 v[144:159], v[172:175], v[52:55], v[144:159]
    ds_read_b64_tr_b16 v[164:165], v10 offset:4096
    ds_read_b64_tr_b16 v[166:167], v10 offset:4608
    s_waitcnt vmcnt(13)
    s_waitcnt lgkmcnt(2)
    v_mfma_f32_32x32x16_bf16 v[128:143], v[160:163], v[56:59], v[128:143]
    ds_read_b64_tr_b16 v[168:169], v9 offset:6144
    ds_read_b64_tr_b16 v[170:171], v9 offset:6656
    s_waitcnt lgkmcnt(2)
    v_mfma_f32_32x32x16_bf16 v[144:159], v[164:167], v[56:59], v[144:159]
    ds_read_b64_tr_b16 v[172:173], v10 offset:6144
    ds_read_b64_tr_b16 v[174:175], v10 offset:6656
    v_add_u32 v9, 49152, v9
    v_add_u32 v10, 49152, v10
    s_waitcnt vmcnt(12)
    s_waitcnt lgkmcnt(2)
    v_mfma_f32_32x32x16_bf16 v[128:143], v[168:171], v[60:63], v[128:143]
    ds_read_b64_tr_b16 v[160:161], v9 offset:0
    ds_read_b64_tr_b16 v[162:163], v9 offset:512
    s_waitcnt lgkmcnt(2)
    v_mfma_f32_32x32x16_bf16 v[144:159], v[172:175], v[60:63], v[144:159]
    ds_read_b64_tr_b16 v[164:165], v10 offset:0
    ds_read_b64_tr_b16 v[166:167], v10 offset:512
    s_waitcnt vmcnt(11)
    s_waitcnt lgkmcnt(2)
    v_mfma_f32_32x32x16_bf16 v[128:143], v[160:163], v[64:67], v[128:143]
    ds_read_b64_tr_b16 v[168:169], v9 offset:2048
    ds_read_b64_tr_b16 v[170:171], v9 offset:2560
    s_waitcnt lgkmcnt(2)
    v_mfma_f32_32x32x16_bf16 v[144:159], v[164:167], v[64:67], v[144:159]
    ds_read_b64_tr_b16 v[172:173], v10 offset:2048
    ds_read_b64_tr_b16 v[174:175], v10 offset:2560
    s_waitcnt vmcnt(10)
    s_waitcnt lgkmcnt(2)
    v_mfma_f32_32x32x16_bf16 v[128:143], v[168:171], v[68:71], v[128:143]
    ds_read_b64_tr_b16 v[160:161], v9 offset:4096
    ds_read_b64_tr_b16 v[162:163], v9 offset:4608
    s_waitcnt lgkmcnt(2)
    v_mfma_f32_32x32x16_bf16 v[144:159], v[172:175], v[68:71], v[144:159]
    ds_read_b64_tr_b16 v[164:165], v10 offset:4096
    ds_read_b64_tr_b16 v[166:167], v10 offset:4608
    s_waitcnt vmcnt(9)
    s_waitcnt lgkmcnt(2)
    v_mfma_f32_32x32x16_bf16 v[128:143], v[160:163], v[72:75], v[128:143]
    ds_read_b64_tr_b16 v[168:169], v9 offset:6144
    ds_read_b64_tr_b16 v[170:171], v9 offset:6656
    s_waitcnt lgkmcnt(2)
    v_mfma_f32_32x32x16_bf16 v[144:159], v[164:167], v[72:75], v[144:159]
    ds_read_b64_tr_b16 v[172:173], v10 offset:6144
    ds_read_b64_tr_b16 v[174:175], v10 offset:6656
    v_add_u32 v9, 65536, v9
    v_add_u32 v10, 65536, v10
    s_waitcnt vmcnt(8)
    s_waitcnt lgkmcnt(2)
    v_mfma_f32_32x32x16_bf16 v[128:143], v[168:171], v[76:79], v[128:143]
    ds_read_b64_tr_b16 v[160:161], v9 offset:0
    ds_read_b64_tr_b16 v[162:163], v9 offset:512
    s_waitcnt lgkmcnt(2)
    v_mfma_f32_32x32x16_bf16 v[144:159], v[172:175], v[76:79], v[144:159]
    ds_read_b64_tr_b16 v[164:165], v10 offset:0
    ds_read_b64_tr_b16 v[166:167], v10 offset:512
    s_waitcnt vmcnt(7)
    s_waitcnt lgkmcnt(2)
    v_mfma_f32_32x32x16_bf16 v[128:143], v[160:163], v[80:83], v[128:143]
    ds_read_b64_tr_b16 v[168:169], v9 offset:2048
    ds_read_b64_tr_b16 v[170:171], v9 offset:2560
    s_waitcnt lgkmcnt(2)
    v_mfma_f32_32x32x16_bf16 v[144:159], v[164:167], v[80:83], v[144:159]
    ds_read_b64_tr_b16 v[172:173], v10 offset:2048
    ds_read_b64_tr_b16 v[174:175], v10 offset:2560
    s_waitcnt vmcnt(6)
    s_waitcnt lgkmcnt(2)
    v_mfma_f32_32x32x16_bf16 v[128:143], v[168:171], v[84:87], v[128:143]
    ds_read_b64_tr_b16 v[160:161], v9 offset:4096
    ds_read_b64_tr_b16 v[162:163], v9 offset:4608
    s_waitcnt lgkmcnt(2)
    v_mfma_f32_32x32x16_bf16 v[144:159], v[172:175], v[84:87], v[144:159]
    ds_read_b64_tr_b16 v[164:165], v10 offset:4096
    ds_read_b64_tr_b16 v[166:167], v10 offset:4608
    s_waitcnt vmcnt(5)
    s_waitcnt lgkmcnt(2)
    v_mfma_f32_32x32x16_bf16 v[128:143], v[160:163], v[88:91], v[128:143]
    ds_read_b64_tr_b16 v[168:169], v9 offset:6144
    ds_read_b64_tr_b16 v[170:171], v9 offset:6656
    s_waitcnt lgkmcnt(2)
    v_mfma_f32_32x32x16_bf16 v[144:159], v[164:167], v[88:91], v[144:159]
    ds_read_b64_tr_b16 v[172:173], v10 offset:6144
    ds_read_b64_tr_b16 v[174:175], v10 offset:6656
    v_add_u32 v9, 4294918144, v9
    v_add_u32 v10, 4294918144, v10
    s_waitcnt vmcnt(4)
    s_waitcnt lgkmcnt(2)
    v_mfma_f32_32x32x16_bf16 v[128:143], v[168:171], v[92:95], v[128:143]
    s_waitcnt lgkmcnt(0)
    v_mfma_f32_32x32x16_bf16 v[144:159], v[172:175], v[92:95], v[144:159]
    v_mov_b32 v204, 1
    ds_write_b32 v5, v204
    s_waitcnt vmcnt(0)
    s_setprio 3
    s_add_u32 s93, s87, 1048576
    v_mov_b32 v12, s11
    s_mov_b64 exec, 1
    buffer_store_dword v12, off, s[68:71], s93 sc1
    s_mov_b64 exec, -1
    s_setprio 2
    s_add_u32 s12, s90, 20480
    buffer_load_dwordx4 v[96:99], v6, s[68:71], s12 offen offset:0 sc1
    buffer_load_dwordx4 v[100:103], v6, s[68:71], s12 offen offset:1024 sc1
    buffer_load_dwordx4 v[104:107], v6, s[68:71], s12 offen offset:2048 sc1
    buffer_load_dwordx4 v[108:111], v6, s[68:71], s12 offen offset:3072 sc1
    s_add_u32 s12, s90, 24576
    buffer_load_dwordx4 v[112:115], v6, s[68:71], s12 offen offset:0 sc1
    buffer_load_dwordx4 v[116:119], v6, s[68:71], s12 offen offset:1024 sc1
    buffer_load_dwordx4 v[120:123], v6, s[68:71], s12 offen offset:2048 sc1
    buffer_load_dwordx4 v[124:127], v6, s[68:71], s12 offen offset:3072 sc1
    s_setprio 0
    ds_read_b32 v206, v14 offset:1024
    s_waitcnt lgkmcnt(0)
    v_cmp_gt_u32 vcc, 1, v206
    s_cbranch_vccnz L_gl1_slow
L_gl1_ok:
    ds_read_b64_tr_b16 v[160:161], v9 offset:0
    ds_read_b64_tr_b16 v[162:163], v9 offset:512
    ds_read_b64_tr_b16 v[164:165], v10 offset:0
    ds_read_b64_tr_b16 v[166:167], v10 offset:512
    s_waitcnt vmcnt(7)
    s_waitcnt lgkmcnt(2)
    v_mfma_f32_32x32x16_bf16 v[128:143], v[160:163], v[96:99], v[128:143]
    ds_read_b64_tr_b16 v[168:169], v9 offset:2048
    ds_read_b64_tr_b16 v[170:171], v9 offset:2560
    s_waitcnt lgkmcnt(2)
    v_mfma_f32_32x32x16_bf16 v[144:159], v[164:167], v[96:99], v[144:159]
    ds_read_b64_tr_b16 v[172:173], v10 offset:2048
    ds_read_b64_tr_b16 v[174:175], v10 offset:2560
    s_waitcnt vmcnt(6)
    s_waitcnt lgkmcnt(2)
    v_mfma_f32_32x32x16_bf16 v[128:143], v[168:171], v[100:103], v[128:143]
    ds_read_b64_tr_b16 v[160:161], v9 offset:4096
    ds_read_b64_tr_b16 v[162:163], v9 offset:4608
    s_waitcnt lgkmcnt(2)
    v_mfma_f32_32x32x16_bf16 v[144:159], v[172:175], v[100:103], v[144:159]
    ds_read_b64_tr_b16 v[164:165], v10 offset:4096
    ds_read_b64_tr_b16 v[166:167], v10 offset:4608
    s_waitcnt vmcnt(5)
    s_waitcnt lgkmcnt(2)
    v_mfma_f32_32x32x16_bf16 v[128:143], v[160:163], v[104:107], v[128:143]
    ds_read_b64_tr_b16 v[168:169], v9 offset:6144
    ds_read_b64_tr_b16 v[170:171], v9 offset:6656
    s_waitcnt lgkmcnt(2)
    v_mfma_f32_32x32x16_bf16 v[144:159], v[164:167], v[104:107], v[144:159]
    ds_read_b64_tr_b16 v[172:173], v10 offset:6144
    ds_read_b64_tr_b16 v[174:175], v10 offset:6656
    v_add_u32 v9, 65536, v9
    v_add_u32 v10, 65536, v10
    s_waitcnt vmcnt(4)
    s_waitcnt lgkmcnt(2)
    v_mfma_f32_32x32x16_bf16 v[128:143], v[168:171], v[108:111], v[128:143]
    ds_read_b64_tr_b16 v[160:161], v9 offset:0
    ds_read_b64_tr_b16 v[162:163], v9 offset:512
    s_waitcnt lgkmcnt(2)
    v_mfma_f32_32x32x16_bf16 v[144:159], v[172:175], v[108:111], v[144:159]
    ds_read_b64_tr_b16 v[164:165], v10 offset:0
    ds_read_b64_tr_b16 v[166:167], v10 offset:512
    buffer_load_dword v8, v7, s[68:71], s89 offen sc1
    s_waitcnt vmcnt(4)
    s_waitcnt lgkmcnt(2)
    v_mfma_f32_32x32x16_bf16 v[128:143], v[160:163], v[112:115], v[128:143]
    ds_read_b64_tr_b16 v[168:169], v9 offset:2048
    ds_read_b64_tr_b16 v[170:171], v9 offset:2560
    s_waitcnt lgkmcnt(2)
    v_mfma_f32_32x32x16_bf16 v[144:159], v[164:167], v[112:115], v[144:159]
    ds_read_b64_tr_b16 v[172:173], v10 offset:2048
    ds_read_b64_tr_b16 v[174:175], v10 offset:2560
    s_waitcnt vmcnt(3)
    s_waitcnt lgkmcnt(2)
    v_mfma_f32_32x32x16_bf16 v[128:143], v[168:171], v[116:119], v[128:143]
    ds_read_b64_tr_b16 v[160:161], v9 offset:4096
    ds_read_b64_tr_b16 v[162:163], v9 offset:4608
    s_waitcnt lgkmcnt(2)
    v_mfma_f32_32x32x16_bf16 v[144:159], v[172:175], v[116:119], v[144:159]
    ds_read_b64_tr_b16 v[164:165], v10 offset:4096
    ds_read_b64_tr_b16 v[166:167], v10 offset:4608
    s_waitcnt vmcnt(2)
    s_waitcnt lgkmcnt(2)
    v_mfma_f32_32x32x16_bf16 v[128:143], v[160:163], v[120:123], v[128:143]
    ds_read_b64_tr_b16 v[168:169], v9 offset:6144
    ds_read_b64_tr_b16 v[170:171], v9 offset:6656
    s_waitcnt lgkmcnt(2)
    v_mfma_f32_32x32x16_bf16 v[144:159], v[164:167], v[120:123], v[144:159]
    ds_read_b64_tr_b16 v[172:173], v10 offset:6144
    ds_read_b64_tr_b16 v[174:175], v10 offset:6656
    v_add_u32 v9, 4294918144, v9
    v_add_u32 v10, 4294918144, v10
    s_waitcnt vmcnt(1)
    s_waitcnt lgkmcnt(2)
    v_mfma_f32_32x32x16_bf16 v[128:143], v[168:171], v[124:127], v[128:143]
    ds_read_b64_tr_b16 v[160:161], v9 offset:0
    ds_read_b64_tr_b16 v[162:163], v9 offset:512
    s_waitcnt lgkmcnt(2)
    v_mfma_f32_32x32x16_bf16 v[144:159], v[172:175], v[124:127], v[144:159]
    ds_read_b64_tr_b16 v[164:165], v10 offset:0
    ds_read_b64_tr_b16 v[166:167], v10 offset:512
    v_mov_b32 v204, 2
    ds_write_b32 v5, v204
    s_waitcnt vmcnt(0)
    v_cmp_ne_u32 vcc, s11, v8
    s_cbranch_vccnz L_gfb_slow
L_gfb_ok:
    s_setprio 0
    s_add_u32 s12, s90, 3670016
    buffer_load_dwordx4 v[208:211], v6, s[68:71], s12 offen offset:0 sc1
    buffer_load_dwordx4 v[212:215], v6, s[68:71], s12 offen offset:1024 sc1
    buffer_load_dwordx4 v[216:219], v6, s[68:71], s12 offen offset:2048 sc1
    buffer_load_dwordx4 v[220:223], v6, s[68:71], s12 offen offset:3072 sc1
    s_add_u32 s12, s90, 3674112
    buffer_load_dwordx4 v[224:227], v6, s[68:71], s12 offen offset:0 sc1
    buffer_load_dwordx4 v[228:231], v6, s[68:71], s12 offen offset:1024 sc1
    buffer_load_dwordx4 v[232:235], v6, s[68:71], s12 offen offset:2048 sc1
    buffer_load_dwordx4 v[236:239], v6, s[68:71], s12 offen offset:3072 sc1
    s_add_u32 s12, s90, 3678208
    buffer_load_dwordx4 v[240:243], v6, s[68:71], s12 offen offset:0 sc1
    buffer_load_dwordx4 v[244:247], v6, s[68:71], s12 offen offset:1024 sc1
    buffer_load_dwordx4 v[248:251], v6, s[68:71], s12 offen offset:2048 sc1
    buffer_load_dwordx4 v[252:255], v6, s[68:71], s12 offen offset:3072 sc1
    s_add_u32 s12, s90, 3682304
    buffer_load_dwordx4 v[16:19], v6, s[68:71], s12 offen offset:0 sc1
    buffer_load_dwordx4 v[20:23], v6, s[68:71], s12 offen offset:1024 sc1
    buffer_load_dwordx4 v[24:27], v6, s[68:71], s12 offen offset:2048 sc1
    buffer_load_dwordx4 v[28:31], v6, s[68:71], s12 offen offset:3072 sc1
    s_setprio 0
    s_waitcnt vmcnt(15)
    s_waitcnt lgkmcnt(3)
    v_mfma_f32_32x32x16_bf16 v[128:143], v[160:163], v[208:211], v[128:143]
    ds_read_b64_tr_b16 v[168:169], v9 offset:2048
    ds_read_b64_tr_b16 v[170:171], v9 offset:2560
    s_waitcnt lgkmcnt(3)
    v_mfma_f32_32x32x16_bf16 v[144:159], v[164:167], v[208:211], v[144:159]
    ds_read_b64_tr_b16 v[172:173], v10 offset:2048
    ds_read_b64_tr_b16 v[174:175], v10 offset:2560
    s_add_u32 s12, s90, 3686400
    buffer_load_dwordx4 v[32:35], v6, s[68:71], s12 offen offset:0 sc1
    s_waitcnt vmcnt(15)
    s_waitcnt lgkmcnt(2)
    v_mfma_f32_32x32x16_bf16 v[128:143], v[168:171], v[212:215], v[128:143]
    ds_read_b64_tr_b16 v[160:161], v9 offset:4096
    ds_read_b64_tr_b16 v[162:163], v9 offset:4608
    s_waitcnt lgkmcnt(2)
    v_mfma_f32_32x32x16_bf16 v[144:159], v[172:175], v[212:215], v[144:159]
    ds_read_b64_tr_b16 v[164:165], v10 offset:4096
    ds_read_b64_tr_b16 v[166:167], v10 offset:4608
    buffer_load_dwordx4 v[36:39], v6, s[68:71], s12 offen offset:1024 sc1
    s_waitcnt vmcnt(15)
    s_waitcnt lgkmcnt(2)
    v_mfma_f32_32x32x16_bf16 v[128:143], v[160:163], v[216:219], v[128:143]
    ds_read_b64_tr_b16 v[168:169], v9 offset:6144
    ds_read_b64_tr_b16 v[170:171], v9 offset:6656
    s_waitcnt lgkmcnt(2)
    v_mfma_f32_32x32x16_bf16 v[144:159], v[164:167], v[216:219], v[144:159]
    ds_read_b64_tr_b16 v[172:173], v10 offset:6144
    ds_read_b64_tr_b16 v[174:175], v10 offset:6656
    buffer_load_dwordx4 v[40:43], v6, s[68:71], s12 offen offset:2048 sc1
    v_add_u32 v9, 4294901760, v9
    v_add_u32 v10, 4294901760, v10
    s_waitcnt vmcnt(15)
    s_waitcnt lgkmcnt(2)
    v_mfma_f32_32x32x16_bf16 v[128:143], v[168:171], v[220:223], v[128:143]
    ds_read_b64_tr_b16 v[160:161], v9 offset:0
    ds_read_b64_tr_b16 v[162:163], v9 offset:512
    s_waitcnt lgkmcnt(2)
    v_mfma_f32_32x32x16_bf16 v[144:159], v[172:175], v[220:223], v[144:159]
    ds_read_b64_tr_b16 v[164:165], v10 offset:0
    ds_read_b64_tr_b16 v[166:167], v10 offset:512
    buffer_load_dwordx4 v[44:47], v6, s[68:71], s12 offen offset:3072 sc1
    s_waitcnt vmcnt(15)
    s_waitcnt lgkmcnt(2)
    v_mfma_f32_32x32x16_bf16 v[128:143], v[160:163], v[224:227], v[128:143]
    ds_read_b64_tr_b16 v[168:169], v9 offset:2048
    ds_read_b64_tr_b16 v[170:171], v9 offset:2560
    s_waitcnt lgkmcnt(2)
    v_mfma_f32_32x32x16_bf16 v[144:159], v[164:167], v[224:227], v[144:159]
    ds_read_b64_tr_b16 v[172:173], v10 offset:2048
    ds_read_b64_tr_b16 v[174:175], v10 offset:2560
    s_add_u32 s12, s90, 3690496
    buffer_load_dwordx4 v[48:51], v6, s[68:71], s12 offen offset:0 sc1
    s_waitcnt vmcnt(15)
    s_waitcnt lgkmcnt(2)
    v_mfma_f32_32x32x16_bf16 v[128:143], v[168:171], v[228:231], v[128:143]
    ds_read_b64_tr_b16 v[160:161], v9 offset:4096
    ds_read_b64_tr_b16 v[162:163], v9 offset:4608
    s_waitcnt lgkmcnt(2)
    v_mfma_f32_32x32x16_bf16 v[144:159], v[172:175], v[228:231], v[144:159]
    ds_read_b64_tr_b16 v[164:165], v10 offset:4096
    ds_read_b64_tr_b16 v[166:167], v10 offset:4608
    buffer_load_dwordx4 v[52:55], v6, s[68:71], s12 offen offset:1024 sc1
    ds_read_b32 v206, v14 offset:1024
    s_waitcnt vmcnt(15)
    s_waitcnt lgkmcnt(3)
    v_mfma_f32_32x32x16_bf16 v[128:143], v[160:163], v[232:235], v[128:143]
    ds_read_b64_tr_b16 v[168:169], v9 offset:6144
    ds_read_b64_tr_b16 v[170:171], v9 offset:6656
    s_waitcnt lgkmcnt(3)
    v_mfma_f32_32x32x16_bf16 v[144:159], v[164:167], v[232:235], v[144:159]
    ds_read_b64_tr_b16 v[172:173], v10 offset:6144
    ds_read_b64_tr_b16 v[174:175], v10 offset:6656
    buffer_load_dwordx4 v[56:59], v6, s[68:71], s12 offen offset:2048 sc1
    s_waitcnt lgkmcnt(4)
    v_cmp_gt_u32 vcc, 2, v206
    s_cbranch_vccnz L_gl9_slow
L_gl9_ok:
    v_add_u32 v9, 81920, v9
    v_add_u32 v10, 81920, v10
    s_waitcnt vmcnt(15)
    s_waitcnt lgkmcnt(2)
    v_mfma_f32_32x32x16_bf16 v[128:143], v[168:171], v[236:239], v[128:143]
    ds_read_b64_tr_b16 v[160:161], v9 offset:0
    ds_read_b64_tr_b16 v[162:163], v9 offset:512
    s_waitcnt lgkmcnt(2)
    v_mfma_f32_32x32x16_bf16 v[144:159], v[172:175], v[236:239], v[144:159]
    ds_read_b64_tr_b16 v[164:165], v10 offset:0
    ds_read_b64_tr_b16 v[166:167], v10 offset:512
    buffer_load_dwordx4 v[60:63], v6, s[68:71], s12 offen offset:3072 sc1
    v_mov_b32 v204, 3
    ds_write_b32 v5, v204
    s_waitcnt vmcnt(15)
    s_waitcnt lgkmcnt(3)
    v_mfma_f32_32x32x16_bf16 v[128:143], v[160:163], v[240:243], v[128:143]
    ds_read_b64_tr_b16 v[168:169], v9 offset:2048
    ds_read_b64_tr_b16 v[170:171], v9 offset:2560
    s_waitcnt lgkmcnt(3)
    v_mfma_f32_32x32x16_bf16 v[144:159], v[164:167], v[240:243], v[144:159]
    ds_read_b64_tr_b16 v[172:173], v10 offset:2048
    ds_read_b64_tr_b16 v[174:175], v10 offset:2560
    s_add_u32 s12, s90, 3694592
    buffer_load_dwordx4 v[64:67], v6, s[68:71], s12 offen offset:0 sc1
    s_waitcnt vmcnt(15)
    s_waitcnt lgkmcnt(2)
    v_mfma_f32_32x32x16_bf16 v[128:143], v[168:171], v[244:247], v[128:143]
    ds_read_b64_tr_b16 v[160:161], v9 offset:4096
    ds_read_b64_tr_b16 v[162:163], v9 offset:4608
    s_waitcnt lgkmcnt(2)
    v_mfma_f32_32x32x16_bf16 v[144:159], v[172:175], v[244:247], v[144:159]
    ds_read_b64_tr_b16 v[164:165], v10 offset:4096
    ds_read_b64_tr_b16 v[166:167], v10 offset:4608
    buffer_load_dwordx4 v[68:71], v6, s[68:71], s12 offen offset:1024 sc1
    s_waitcnt vmcnt(15)
    s_waitcnt lgkmcnt(2)
    v_mfma_f32_32x32x16_bf16 v[128:143], v[160:163], v[248:251], v[128:143]
    ds_read_b64_tr_b16 v[168:169], v9 offset:6144
    ds_read_b64_tr_b16 v[170:171], v9 offset:6656
    s_waitcnt lgkmcnt(2)
    v_mfma_f32_32x32x16_bf16 v[144:159], v[164:167], v[248:251], v[144:159]
    ds_read_b64_tr_b16 v[172:173], v10 offset:6144
    ds_read_b64_tr_b16 v[174:175], v10 offset:6656
    buffer_load_dwordx4 v[72:75], v6, s[68:71], s12 offen offset:2048 sc1
    v_add_u32 v9, 4294901760, v9
    v_add_u32 v10, 4294901760, v10
    s_waitcnt vmcnt(15)
    s_waitcnt lgkmcnt(2)
    v_mfma_f32_32x32x16_bf16 v[128:143], v[168:171], v[252:255], v[128:143]
    ds_read_b64_tr_b16 v[160:161], v9 offset:0
    ds_read_b64_tr_b16 v[162:163], v9 offset:512
    s_waitcnt lgkmcnt(2)
    v_mfma_f32_32x32x16_bf16 v[144:159], v[172:175], v[252:255], v[144:159]
    ds_read_b64_tr_b16 v[164:165], v10 offset:0
    ds_read_b64_tr_b16 v[166:167], v10 offset:512
    buffer_load_dwordx4 v[76:79], v6, s[68:71], s12 offen offset:3072 sc1
    s_waitcnt vmcnt(15)
    s_waitcnt lgkmcnt(2)
    v_mfma_f32_32x32x16_bf16 v[128:143], v[160:163], v[16:19], v[128:143]
    ds_read_b64_tr_b16 v[168:169], v9 offset:2048
    ds_read_b64_tr_b16 v[170:171], v9 offset:2560
    s_waitcnt lgkmcnt(2)
    v_mfma_f32_32x32x16_bf16 v[144:159], v[164:167], v[16:19], v[144:159]
    ds_read_b64_tr_b16 v[172:173], v10 offset:2048
    ds_read_b64_tr_b16 v[174:175], v10 offset:2560
    s_waitcnt vmcnt(14)
    s_waitcnt lgkmcnt(2)
    v_mfma_f32_32x32x16_bf16 v[128:143], v[168:171], v[20:23], v[128:143]
    ds_read_b64_tr_b16 v[160:161], v9 offset:4096
    ds_read_b64_tr_b16 v[162:163], v9 offset:4608
    s_waitcnt lgkmcnt(2)
    v_mfma_f32_32x32x16_bf16 v[144:159], v[172:175], v[20:23], v[144:159]
    ds_read_b64_tr_b16 v[164:165], v10 offset:4096
    ds_read_b64_tr_b16 v[166:167], v10 offset:4608
    s_waitcnt vmcnt(13)
    s_waitcnt lgkmcnt(2)
    v_mfma_f32_32x32x16_bf16 v[128:143], v[160:163], v[24:27], v[128:143]
    ds_read_b64_tr_b16 v[168:169], v9 offset:6144
    ds_read_b64_tr_b16 v[170:171], v9 offset:6656
    s_waitcnt lgkmcnt(2)
    v_mfma_f32_32x32x16_bf16 v[144:159], v[164:167], v[24:27], v[144:159]
    ds_read_b64_tr_b16 v[172:173], v10 offset:6144
    ds_read_b64_tr_b16 v[174:175], v10 offset:6656
    v_add_u32 v9, 4294934528, v9
    v_add_u32 v10, 4294934528, v10
    s_waitcnt vmcnt(12)
    s_waitcnt lgkmcnt(2)
    v_mfma_f32_32x32x16_bf16 v[128:143], v[168:171], v[28:31], v[128:143]
    ds_read_b64_tr_b16 v[160:161], v9 offset:0
    ds_read_b64_tr_b16 v[162:163], v9 offset:512
    s_waitcnt lgkmcnt(2)
    v_mfma_f32_32x32x16_bf16 v[144:159], v[172:175], v[28:31], v[144:159]
    ds_read_b64_tr_b16 v[164:165], v10 offset:0
    ds_read_b64_tr_b16 v[166:167], v10 offset:512
    s_waitcnt vmcnt(11)
    s_waitcnt lgkmcnt(2)
    v_mfma_f32_32x32x16_bf16 v[128:143], v[160:163], v[32:35], v[128:143]
    ds_read_b64_tr_b16 v[168:169], v9 offset:2048
    ds_read_b64_tr_b16 v[170:171], v9 offset:2560
    s_waitcnt lgkmcnt(2)
    v_mfma_f32_32x32x16_bf16 v[144:159], v[164:167], v[32:35], v[144:159]
    ds_read_b64_tr_b16 v[172:173], v10 offset:2048
    ds_read_b64_tr_b16 v[174:175], v10 offset:2560
    s_waitcnt vmcnt(10)
    s_waitcnt lgkmcnt(2)
    v_mfma_f32_32x32x16_bf16 v[128:143], v[168:171], v[36:39], v[128:143]
    ds_read_b64_tr_b16 v[160:161], v9 offset:4096
    ds_read_b64_tr_b16 v[162:163], v9 offset:4608
    s_waitcnt lgkmcnt(2)
    v_mfma_f32_32x32x16_bf16 v[144:159], v[172:175], v[36:39], v[144:159]
    ds_read_b64_tr_b16 v[164:165], v10 offset:4096
    ds_read_b64_tr_b16 v[166:167], v10 offset:4608
    s_waitcnt vmcnt(9)
    s_waitcnt lgkmcnt(2)
    v_mfma_f32_32x32x16_bf16 v[128:143], v[160:163], v[40:43], v[128:143]
    ds_read_b64_tr_b16 v[168:169], v9 offset:6144
    ds_read_b64_tr_b16 v[170:171], v9 offset:6656
    s_waitcnt lgkmcnt(2)
    v_mfma_f32_32x32x16_bf16 v[144:159], v[164:167], v[40:43], v[144:159]
    ds_read_b64_tr_b16 v[172:173], v10 offset:6144
    ds_read_b64_tr_b16 v[174:175], v10 offset:6656
    v_add_u32 v9, 49152, v9
    v_add_u32 v10, 49152, v10
    s_waitcnt vmcnt(8)
    s_waitcnt lgkmcnt(2)
    v_mfma_f32_32x32x16_bf16 v[128:143], v[168:171], v[44:47], v[128:143]
    ds_read_b64_tr_b16 v[160:161], v9 offset:0
    ds_read_b64_tr_b16 v[162:163], v9 offset:512
    s_waitcnt lgkmcnt(2)
    v_mfma_f32_32x32x16_bf16 v[144:159], v[172:175], v[44:47], v[144:159]
    ds_read_b64_tr_b16 v[164:165], v10 offset:0
    ds_read_b64_tr_b16 v[166:167], v10 offset:512
    s_waitcnt vmcnt(7)
    s_waitcnt lgkmcnt(2)
    v_mfma_f32_32x32x16_bf16 v[128:143], v[160:163], v[48:51], v[128:143]
    ds_read_b64_tr_b16 v[168:169], v9 offset:2048
    ds_read_b64_tr_b16 v[170:171], v9 offset:2560
    s_waitcnt lgkmcnt(2)
    v_mfma_f32_32x32x16_bf16 v[144:159], v[164:167], v[48:51], v[144:159]
    ds_read_b64_tr_b16 v[172:173], v10 offset:2048
    ds_read_b64_tr_b16 v[174:175], v10 offset:2560
    v_lshlrev_b32 v205, 4, v0
    v_add_u32 v205, 147456, v205
    v_lshlrev_b32 v206, 2, v0
    v_add_u32 v206, 155648, v206
    s_waitcnt vmcnt(6)
    s_waitcnt lgkmcnt(2)
    v_mfma_f32_32x32x16_bf16 v[128:143], v[168:171], v[52:55], v[128:143]
    ds_read_b64_tr_b16 v[160:161], v9 offset:4096
    ds_read_b64_tr_b16 v[162:163], v9 offset:4608
    s_waitcnt lgkmcnt(2)
    v_mfma_f32_32x32x16_bf16 v[144:159], v[172:175], v[52:55], v[144:159]
    ds_read_b64_tr_b16 v[164:165], v10 offset:4096
    ds_read_b64_tr_b16 v[166:167], v10 offset:4608
    s_waitcnt vmcnt(5)
    s_waitcnt lgkmcnt(2)
    v_mfma_f32_32x32x16_bf16 v[128:143], v[160:163], v[56:59], v[128:143]
    ds_read_b64_tr_b16 v[168:169], v9 offset:6144
    ds_read_b64_tr_b16 v[170:171], v9 offset:6656
    s_waitcnt lgkmcnt(2)
    v_mfma_f32_32x32x16_bf16 v[144:159], v[164:167], v[56:59], v[144:159]
    ds_read_b64_tr_b16 v[172:173], v10 offset:6144
    ds_read_b64_tr_b16 v[174:175], v10 offset:6656
    ds_read_b32 v204, v14 offset:0
    v_add_u32 v9, 65536, v9
    v_add_u32 v10, 65536, v10
    s_waitcnt vmcnt(4)
    s_waitcnt lgkmcnt(3)
    v_mfma_f32_32x32x16_bf16 v[128:143], v[168:171], v[60:63], v[128:143]
    ds_read_b64_tr_b16 v[160:161], v9 offset:0
    ds_read_b64_tr_b16 v[162:163], v9 offset:512
    s_waitcnt lgkmcnt(3)
    v_mfma_f32_32x32x16_bf16 v[144:159], v[172:175], v[60:63], v[144:159]
    ds_read_b64_tr_b16 v[164:165], v10 offset:0
    ds_read_b64_tr_b16 v[166:167], v10 offset:512
    s_waitcnt vmcnt(3)
    s_waitcnt lgkmcnt(2)
    v_mfma_f32_32x32x16_bf16 v[128:143], v[160:163], v[64:67], v[128:143]
    ds_read_b64_tr_b16 v[168:169], v9 offset:2048
    ds_read_b64_tr_b16 v[170:171], v9 offset:2560
    s_waitcnt lgkmcnt(2)
    v_mfma_f32_32x32x16_bf16 v[144:159], v[164:167], v[64:67], v[144:159]
    ds_read_b64_tr_b16 v[172:173], v10 offset:2048
    ds_read_b64_tr_b16 v[174:175], v10 offset:2560
    v_cmp_gt_u32 vcc, 3, v204
    s_cbranch_vccnz L_gp2_slow
L_gp2_ok:
    s_waitcnt vmcnt(2)
    s_waitcnt lgkmcnt(2)
    v_mfma_f32_32x32x16_bf16 v[128:143], v[168:171], v[68:71], v[128:143]
    ds_read_b64_tr_b16 v[160:161], v9 offset:4096
    ds_read_b64_tr_b16 v[162:163], v9 offset:4608
    s_waitcnt lgkmcnt(2)
    v_mfma_f32_32x32x16_bf16 v[144:159], v[172:175], v[68:71], v[144:159]
    ds_read_b64_tr_b16 v[164:165], v10 offset:4096
    ds_read_b64_tr_b16 v[166:167], v10 offset:4608
    s_waitcnt vmcnt(1)
    s_waitcnt lgkmcnt(2)
    v_mfma_f32_32x32x16_bf16 v[128:143], v[160:163], v[72:75], v[128:143]
    ds_read_b64_tr_b16 v[168:169], v9 offset:6144
    ds_read_b64_tr_b16 v[170:171], v9 offset:6656
    s_waitcnt lgkmcnt(2)
    v_mfma_f32_32x32x16_bf16 v[144:159], v[164:167], v[72:75], v[144:159]
    ds_read_b64_tr_b16 v[172:173], v10 offset:6144
    ds_read_b64_tr_b16 v[174:175], v10 offset:6656
    s_waitcnt vmcnt(0)
    s_waitcnt lgkmcnt(2)
    v_mfma_f32_32x32x16_bf16 v[128:143], v[168:171], v[76:79], v[128:143]
    s_waitcnt lgkmcnt(0)
    v_mfma_f32_32x32x16_bf16 v[144:159], v[172:175], v[76:79], v[144:159]
    v_xor_b32 v9, 0, v13
    s_nop 8
    ds_write_b128 v9, v[128:131] offset:0
    v_xor_b32 v9, 32, v13
    ds_write_b128 v9, v[132:135] offset:0
    v_xor_b32 v9, 64, v13
    ds_write_b128 v9, v[136:139] offset:0
    v_xor_b32 v9, 96, v13
    ds_write_b128 v9, v[140:143] offset:0
    v_xor_b32 v10, 128, v13
    ds_write_b128 v10, v[144:147] offset:0
    v_xor_b32 v10, 160, v13
    ds_write_b128 v10, v[148:151] offset:0
    v_xor_b32 v10, 192, v13
    ds_write_b128 v10, v[152:155] offset:0
    v_xor_b32 v10, 224, v13
    ds_write_b128 v10, v[156:159] offset:0
    v_add_u32 v3, 81920, v4
    v_add_u32 v4, 16384, v4
    v_xor_b32 v5, 128, v3
    v_xor_b32 v200, 128, v4
    s_waitcnt lgkmcnt(0)
    s_barrier
    ds_read_b32 v203, v206
    ds_read_b128 v[16:19], v3
    ds_read_b128 v[24:27], v4
    ds_read_b128 v[20:23], v5
    ds_read_b128 v[28:31], v200
    ds_read_b128 v[184:187], v205
    ds_read_b128 v[188:191], v205 offset:4096
    ds_read_b128 v[32:35], v205 offset:12288
    s_waitcnt lgkmcnt(5)
    v_add_f32 v16, v16, v24
    v_add_f32 v17, v17, v25
    v_add_f32 v18, v18, v26
    v_add_f32 v19, v19, v27
    v_mul_f32 v24, v203, v16
    v_mul_f32 v25, v203, v17
    v_mul_f32 v26, v203, v18
    v_mul_f32 v27, v203, v19
    v_exp_f32 v24, v24
    v_exp_f32 v25, v25
    v_exp_f32 v26, v26
    v_exp_f32 v27, v27
    v_add_f32 v24, 1.0, v24
    v_add_f32 v25, 1.0, v25
    v_add_f32 v26, 1.0, v26
    v_add_f32 v27, 1.0, v27
    s_waitcnt lgkmcnt(0)
    v_rcp_f32 v24, v24
    v_mul_f32 v16, v184, v16
    v_lshlrev_b32 v176, 16, v32
    v_rcp_f32 v25, v25
    v_mul_f32 v17, v185, v17
    v_and_b32 v177, 0xffff0000, v32
    v_rcp_f32 v26, v26
    v_mul_f32 v18, v186, v18
    v_lshlrev_b32 v178, 16, v33
    v_rcp_f32 v27, v27
    v_mul_f32 v19, v187, v19
    v_and_b32 v179, 0xffff0000, v33
    v_fmac_f32 v176, v16, v24
    v_fmac_f32 v177, v17, v25
    v_fmac_f32 v178, v18, v26
    v_fmac_f32 v179, v19, v27
    buffer_store_dwordx4 v[176:179], v2, s[72:75], s98 offen sc1
    v_add_f32 v20, v20, v28
    v_add_f32 v21, v21, v29
    v_add_f32 v22, v22, v30
    v_add_f32 v23, v23, v31
    v_mul_f32 v28, v203, v20
    v_mul_f32 v29, v203, v21
    v_mul_f32 v30, v203, v22
    v_mul_f32 v31, v203, v23
    v_exp_f32 v28, v28
    v_exp_f32 v29, v29
    v_exp_f32 v30, v30
    v_exp_f32 v31, v31
    v_add_f32 v28, 1.0, v28
    v_add_f32 v29, 1.0, v29
    v_add_f32 v30, 1.0, v30
    v_add_f32 v31, 1.0, v31
    v_rcp_f32 v28, v28
    v_mul_f32 v20, v188, v20
    v_lshlrev_b32 v180, 16, v34
    v_rcp_f32 v29, v29
    v_mul_f32 v21, v189, v21
    v_and_b32 v181, 0xffff0000, v34
    v_rcp_f32 v30, v30
    v_mul_f32 v22, v190, v22
    v_lshlrev_b32 v182, 16, v35
    v_rcp_f32 v31, v31
    v_mul_f32 v23, v191, v23
    v_and_b32 v183, 0xffff0000, v35
    v_fmac_f32 v180, v20, v28
    v_fmac_f32 v181, v21, v29
    v_fmac_f32 v182, v22, v30
    v_fmac_f32 v183, v23, v31
    buffer_store_dwordx4 v[180:183], v2, s[72:75], s98 offen offset:128 sc1
    s_cmp_lg_u32 s7, 31
    s_cbranch_scc1 L_nobump
    s_or_b32 s12, s8, s4
    s_cmp_lg_u32 s12, 0
    s_cbranch_scc1 L_nobump
    v_mov_b32 v6, s11
    s_mov_b32 s12, 12124160
    buffer_store_dword v6, off, s[68:71], s12 sc1
L_nobump:
    s_endpgm
L_helper:
    s_nop 1
    s_mov_b32 s96, 0x3f803f80
    s_lshl_b32 s5, s10, 2
    s_lshr_b32 s12, s9, 1
    s_add_u32 s5, s5, s12
    s_and_b32 s6, s9, 1
    s_mul_i32 s7, s6, 14
    s_add_u32 s7, s7, s5
    s_lshl_b32 s8, s6, 4
    s_add_u32 s8, s8, s5
    s_lshl_b32 s80, s8, 2
    s_add_u32 s80, s80, s4
    s_lshr_b32 s12, s3, 2
    s_lshl_b32 s12, s12, 7
    s_add_u32 s80, s80, s12
    v_lshlrev_b32 v7, 4, v7
    v_mul_u32_u24 v2, 896, v6
    v_add_u32 v2, v2, v7
    v_mul_u32_u24 v3, 3584, v6
    v_add_u32 v3, v3, v7
    s_cmp_ge_u32 s80, 56
    s_cselect_b32 s12, 56, 0
    s_sub_u32 s81, s80, s12
    s_mul_i32 s81, s81, 7168
    s_mul_i32 s82, s3, 200704
    s_and_b32 s85, s7, 1
    s_lshr_b32 s7, s7, 1
    s_lshl_b32 s12, s7, 8
    s_add_u32 s82, s82, s12
    s_mov_b32 s83, 0x3f80
    s_mov_b32 s84, 0x3f800000
    s_waitcnt lgkmcnt(0)
    s_add_u32 s34, s46, 12124160
    s_addc_u32 s35, s47, 0
    s_load_dword s11, s[34:35], 0
    s_cmp_ge_u32 s80, 56
    s_cselect_b32 s52, s24, s22
    s_cselect_b32 s53, s25, s23
    s_mov_b32 s52, s52
    s_and_b32 s53, s53, 0xffff
    s_mov_b32 s54, 401408
    s_mov_b32 s55, 0x20000
    s_cmp_ge_u32 s80, 112
    s_cbranch_scc1 L_hskipb
    buffer_load_dwordx4 v[16:19], v2, s[52:55], s81 offen offset:0
    buffer_load_dwordx4 v[20:23], v2, s[52:55], s81 offen offset:128
    buffer_load_dwordx4 v[24:27], v2, s[52:55], s81 offen offset:256
    buffer_load_dwordx4 v[28:31], v2, s[52:55], s81 offen offset:384
    buffer_load_dwordx4 v[32:35], v2, s[52:55], s81 offen offset:512
    buffer_load_dwordx4 v[36:39], v2, s[52:55], s81 offen offset:640
    buffer_load_dwordx4 v[40:43], v2, s[52:55], s81 offen offset:768
L_hskipb:
    s_cmp_eq_u32 s85, 1
    s_cselect_b32 s48, s38, s36
    s_cselect_b32 s49, s39, s37
    s_mov_b32 s48, s48
    s_and_b32 s49, s49, 0xffff
    s_mov_b32 s50, 1605632
    s_mov_b32 s51, 0x20000
    s_cmp_ge_u32 s5, 14
    s_cselect_b32 s50, 0, s50
    s_cselect_b32 s82, 0, s82
    s_add_u32 s86, s82, 0
    buffer_load_dwordx4 v[48:51], v3, s[48:51], s86 offen
    s_add_u32 s86, s82, 28672
    buffer_load_dwordx4 v[52:55], v3, s[48:51], s86 offen
    s_mov_b32 s56, s46
    s_and_b32 s57, s47, 0xffff
    s_mov_b32 s58, 14680064
    s_mov_b32 s59, 0x20000
    s_waitcnt lgkmcnt(0)
    s_mul_i32 s11, s11, 1664525
    s_add_u32 s11, s11, 1013904223
    v_mov_b32 v112, 0
    v_mov_b32 v113, 0
    v_mov_b32 v114, 0
    v_mov_b32 v115, 0
    v_mov_b32 v116, 0
    v_mov_b32 v117, 0
    v_mov_b32 v118, 0
    v_mov_b32 v119, 0
    v_mov_b32 v120, 0
    v_mov_b32 v121, 0
    v_mov_b32 v122, 0
    v_mov_b32 v123, 0
    s_cmp_ge_u32 s80, 112
    s_cbranch_scc1 L_hnob
    s_waitcnt vmcnt(8)
    v_dot2_f32_bf16 v120, v16, s96, v120
    v_dot2_f32_bf16 v121, v17, s96, v121
    v_dot2_f32_bf16 v122, v18, s96, v122
    v_dot2_f32_bf16 v123, v19, s96, v123
    s_waitcnt vmcnt(7)
    v_dot2_f32_bf16 v120, v20, s96, v120
    v_dot2_f32_bf16 v121, v21, s96, v121
    v_dot2_f32_bf16 v122, v22, s96, v122
    v_dot2_f32_bf16 v123, v23, s96, v123
    s_waitcnt vmcnt(6)
    v_dot2_f32_bf16 v120, v24, s96, v120
    v_dot2_f32_bf16 v121, v25, s96, v121
    v_dot2_f32_bf16 v122, v26, s96, v122
    v_dot2_f32_bf16 v123, v27, s96, v123
    s_waitcnt vmcnt(5)
    v_dot2_f32_bf16 v120, v28, s96, v120
    v_dot2_f32_bf16 v121, v29, s96, v121
    v_dot2_f32_bf16 v122, v30, s96, v122
    v_dot2_f32_bf16 v123, v31, s96, v123
    s_waitcnt vmcnt(4)
    v_dot2_f32_bf16 v120, v32, s96, v120
    v_dot2_f32_bf16 v121, v33, s96, v121
    v_dot2_f32_bf16 v122, v34, s96, v122
    v_dot2_f32_bf16 v123, v35, s96, v123
    s_waitcnt vmcnt(3)
    v_dot2_f32_bf16 v120, v36, s96, v120
    v_dot2_f32_bf16 v121, v37, s96, v121
    v_dot2_f32_bf16 v122, v38, s96, v122
    v_dot2_f32_bf16 v123, v39, s96, v123
    s_waitcnt vmcnt(2)
    v_dot2_f32_bf16 v120, v40, s96, v120
    v_dot2_f32_bf16 v121, v41, s96, v121
    v_dot2_f32_bf16 v122, v42, s96, v122
    v_dot2_f32_bf16 v123, v43, s96, v123
    s_nop 0
    v_add_f32 v120, v120, v121
    s_nop 0
    v_add_f32 v122, v122, v123
    v_add_f32 v120, v120, v122
    ds_swizzle_b32 v121, v120 offset:1055
    s_waitcnt lgkmcnt(0)
    v_add_f32 v120, v120, v121
    ds_swizzle_b32 v121, v120 offset:2079
    s_waitcnt lgkmcnt(0)
    v_add_f32 v120, v120, v121
    ds_swizzle_b32 v121, v120 offset:4127
    s_waitcnt lgkmcnt(0)
    v_add_f32 v120, v120, v121
    v_cvt_pk_bf16_f32 v122, v120, v120
    v_and_b32 v122, 0xffff0000, v122
    v_sub_f32 v120, v120, v122
    v_cvt_pk_bf16_f32 v120, v120, v122
    v_mov_b32 v121, s11
    v_lshlrev_b32 v4, 3, v6
    s_lshl_b32 s12, s80, 6
    s_add_u32 s12, s12, 12255232
    buffer_store_dwordx2 v[120:121], v4, s[56:59], s12 offen sc1
L_hnob:
    s_add_u32 s86, s82, 57344
    buffer_load_dwordx4 v[56:59], v3, s[48:51], s86 offen
    s_add_u32 s86, s82, 86016
    buffer_load_dwordx4 v[60:63], v3, s[48:51], s86 offen
    s_add_u32 s86, s82, 114688
    buffer_load_dwordx4 v[64:67], v3, s[48:51], s86 offen
    s_add_u32 s86, s82, 143360
    buffer_load_dwordx4 v[68:71], v3, s[48:51], s86 offen
    s_add_u32 s86, s82, 172032
    buffer_load_dwordx4 v[72:75], v3, s[48:51], s86 offen
    s_add_u32 s86, s82, 128
    buffer_load_dwordx4 v[76:79], v3, s[48:51], s86 offen
    s_add_u32 s86, s82, 28800
    buffer_load_dwordx4 v[80:83], v3, s[48:51], s86 offen
    s_add_u32 s86, s82, 57472
    buffer_load_dwordx4 v[84:87], v3, s[48:51], s86 offen
    s_add_u32 s86, s82, 86144
    buffer_load_dwordx4 v[88:91], v3, s[48:51], s86 offen
    s_add_u32 s86, s82, 114816
    buffer_load_dwordx4 v[92:95], v3, s[48:51], s86 offen
    s_add_u32 s86, s82, 143488
    buffer_load_dwordx4 v[96:99], v3, s[48:51], s86 offen
    s_add_u32 s86, s82, 172160
    buffer_load_dwordx4 v[100:103], v3, s[48:51], s86 offen
    v_lshlrev_b32 v4, 5, v1
    s_lshl_b32 s12, s3, 11
    v_add_u32 v4, s12, v4
    v_lshlrev_b32 v5, 2, v1
    v_lshlrev_b32 v8, 3, v1
    s_mul_i32 s12, s85, 14
    s_add_u32 s12, s12, s7
    s_lshl_b32 s12, s12, 10
    s_add_u32 s86, s12, 12189696
    s_waitcnt vmcnt(13)
    v_dot2_f32_bf16 v112, v48, s83, 0
    v_dot2_f32_bf16 v113, v48, s84, 0
    v_dot2_f32_bf16 v114, v49, s83, 0
    v_dot2_f32_bf16 v115, v49, s84, 0
    v_dot2_f32_bf16 v116, v50, s83, 0
    v_dot2_f32_bf16 v117, v50, s84, 0
    v_dot2_f32_bf16 v118, v51, s83, 0
    v_dot2_f32_bf16 v119, v51, s84, 0
    s_waitcnt vmcnt(12)
    v_dot2_f32_bf16 v112, v52, s83, v112
    v_dot2_f32_bf16 v113, v52, s84, v113
    v_dot2_f32_bf16 v114, v53, s83, v114
    v_dot2_f32_bf16 v115, v53, s84, v115
    v_dot2_f32_bf16 v116, v54, s83, v116
    v_dot2_f32_bf16 v117, v54, s84, v117
    v_dot2_f32_bf16 v118, v55, s83, v118
    v_dot2_f32_bf16 v119, v55, s84, v119
    s_waitcnt vmcnt(11)
    v_dot2_f32_bf16 v112, v56, s83, v112
    v_dot2_f32_bf16 v113, v56, s84, v113
    v_dot2_f32_bf16 v114, v57, s83, v114
    v_dot2_f32_bf16 v115, v57, s84, v115
    v_dot2_f32_bf16 v116, v58, s83, v116
    v_dot2_f32_bf16 v117, v58, s84, v117
    v_dot2_f32_bf16 v118, v59, s83, v118
    v_dot2_f32_bf16 v119, v59, s84, v119
    s_waitcnt vmcnt(10)
    v_dot2_f32_bf16 v112, v60, s83, v112
    v_dot2_f32_bf16 v113, v60, s84, v113
    v_dot2_f32_bf16 v114, v61, s83, v114
    v_dot2_f32_bf16 v115, v61, s84, v115
    v_dot2_f32_bf16 v116, v62, s83, v116
    v_dot2_f32_bf16 v117, v62, s84, v117
    v_dot2_f32_bf16 v118, v63, s83, v118
    v_dot2_f32_bf16 v119, v63, s84, v119
    s_waitcnt vmcnt(9)
    v_dot2_f32_bf16 v112, v64, s83, v112
    v_dot2_f32_bf16 v113, v64, s84, v113
    v_dot2_f32_bf16 v114, v65, s83, v114
    v_dot2_f32_bf16 v115, v65, s84, v115
    v_dot2_f32_bf16 v116, v66, s83, v116
    v_dot2_f32_bf16 v117, v66, s84, v117
    v_dot2_f32_bf16 v118, v67, s83, v118
    v_dot2_f32_bf16 v119, v67, s84, v119
    s_waitcnt vmcnt(8)
    v_dot2_f32_bf16 v112, v68, s83, v112
    v_dot2_f32_bf16 v113, v68, s84, v113
    v_dot2_f32_bf16 v114, v69, s83, v114
    v_dot2_f32_bf16 v115, v69, s84, v115
    v_dot2_f32_bf16 v116, v70, s83, v116
    v_dot2_f32_bf16 v117, v70, s84, v117
    v_dot2_f32_bf16 v118, v71, s83, v118
    v_dot2_f32_bf16 v119, v71, s84, v119
    s_waitcnt vmcnt(7)
    v_dot2_f32_bf16 v112, v72, s83, v112
    v_dot2_f32_bf16 v113, v72, s84, v113
    v_dot2_f32_bf16 v114, v73, s83, v114
    v_dot2_f32_bf16 v115, v73, s84, v115
    v_dot2_f32_bf16 v116, v74, s83, v116
    v_dot2_f32_bf16 v117, v74, s84, v117
    v_dot2_f32_bf16 v118, v75, s83, v118
    v_dot2_f32_bf16 v119, v75, s84, v119
    ds_write_b128 v4, v[112:115] offset:0
    s_nop 1
    ds_write_b128 v4, v[116:119] offset:16
    s_waitcnt lgkmcnt(0)
    s_barrier
    s_cmp_lg_u32 s3, 7
    s_cbranch_scc1 L_hr0
    s_cmp_ge_u32 s5, 14
    s_cbranch_scc1 L_hr0
    ds_read2st64_b32 v[128:129], v5 offset0:0 offset1:1
    ds_read2st64_b32 v[130:131], v5 offset0:2 offset1:3
    ds_read2st64_b32 v[132:133], v5 offset0:4 offset1:5
    ds_read2st64_b32 v[134:135], v5 offset0:6 offset1:7
    ds_read2st64_b32 v[136:137], v5 offset0:8 offset1:9
    ds_read2st64_b32 v[138:139], v5 offset0:10 offset1:11
    ds_read2st64_b32 v[140:141], v5 offset0:12 offset1:13
    ds_read2st64_b32 v[142:143], v5 offset0:14 offset1:15
    ds_read2st64_b32 v[144:145], v5 offset0:16 offset1:17
    ds_read2st64_b32 v[146:147], v5 offset0:18 offset1:19
    ds_read2st64_b32 v[148:149], v5 offset0:20 offset1:21
    ds_read2st64_b32 v[150:151], v5 offset0:22 offset1:23
    s_waitcnt lgkmcnt(0)
    ds_read2st64_b32 v[152:153], v5 offset0:24 offset1:25
    ds_read2st64_b32 v[154:155], v5 offset0:26 offset1:27
    ds_read2st64_b32 v[156:157], v5 offset0:28 offset1:29
    ds_read2st64_b32 v[158:159], v5 offset0:30 offset1:31
    ds_read2st64_b32 v[160:161], v5 offset0:32 offset1:33
    ds_read2st64_b32 v[162:163], v5 offset0:34 offset1:35
    ds_read2st64_b32 v[164:165], v5 offset0:36 offset1:37
    ds_read2st64_b32 v[166:167], v5 offset0:38 offset1:39
    ds_read2st64_b32 v[168:169], v5 offset0:40 offset1:41
    ds_read2st64_b32 v[170:171], v5 offset0:42 offset1:43
    ds_read2st64_b32 v[172:173], v5 offset0:44 offset1:45
    ds_read2st64_b32 v[174:175], v5 offset0:46 offset1:47
    s_waitcnt lgkmcnt(0)
    ds_read2st64_b32 v[176:177], v5 offset0:48 offset1:49
    ds_read2st64_b32 v[178:179], v5 offset0:50 offset1:51
    ds_read2st64_b32 v[180:181], v5 offset0:52 offset1:53
    ds_read2st64_b32 v[182:183], v5 offset0:54 offset1:55
    ds_read2st64_b32 v[184:185], v5 offset0:56 offset1:57
    ds_read2st64_b32 v[186:187], v5 offset0:58 offset1:59
    ds_read2st64_b32 v[188:189], v5 offset0:60 offset1:61
    ds_read2st64_b32 v[190:191], v5 offset0:62 offset1:63
    s_waitcnt lgkmcnt(0)
    v_add_f32 v128, v128, v160
    v_add_f32 v129, v129, v161
    v_add_f32 v130, v130, v162
    v_add_f32 v131, v131, v163
    v_add_f32 v132, v132, v164
    v_add_f32 v133, v133, v165
    v_add_f32 v134, v134, v166
    v_add_f32 v135, v135, v167
    v_add_f32 v136, v136, v168
    v_add_f32 v137, v137, v169
    v_add_f32 v138, v138, v170
    v_add_f32 v139, v139, v171
    v_add_f32 v140, v140, v172
    v_add_f32 v141, v141, v173
    v_add_f32 v142, v142, v174
    v_add_f32 v143, v143, v175
    v_add_f32 v144, v144, v176
    v_add_f32 v145, v145, v177
    v_add_f32 v146, v146, v178
    v_add_f32 v147, v147, v179
    v_add_f32 v148, v148, v180
    v_add_f32 v149, v149, v181
    v_add_f32 v150, v150, v182
    v_add_f32 v151, v151, v183
    v_add_f32 v152, v152, v184
    v_add_f32 v153, v153, v185
    v_add_f32 v154, v154, v186
    v_add_f32 v155, v155, v187
    v_add_f32 v156, v156, v188
    v_add_f32 v157, v157, v189
    v_add_f32 v158, v158, v190
    v_add_f32 v159, v159, v191
    v_add_f32 v128, v128, v144
    v_add_f32 v129, v129, v145
    v_add_f32 v130, v130, v146
    v_add_f32 v131, v131, v147
    v_add_f32 v132, v132, v148
    v_add_f32 v133, v133, v149
    v_add_f32 v134, v134, v150
    v_add_f32 v135, v135, v151
    v_add_f32 v136, v136, v152
    v_add_f32 v137, v137, v153
    v_add_f32 v138, v138, v154
    v_add_f32 v139, v139, v155
    v_add_f32 v140, v140, v156
    v_add_f32 v141, v141, v157
    v_add_f32 v142, v142, v158
    v_add_f32 v143, v143, v159
    v_add_f32 v128, v128, v136
    v_add_f32 v129, v129, v137
    v_add_f32 v130, v130, v138
    v_add_f32 v131, v131, v139
    v_add_f32 v132, v132, v140
    v_add_f32 v133, v133, v141
    v_add_f32 v134, v134, v142
    v_add_f32 v135, v135, v143
    v_add_f32 v128, v128, v132
    v_add_f32 v129, v129, v133
    v_add_f32 v130, v130, v134
    v_add_f32 v131, v131, v135
    v_add_f32 v128, v128, v130
    v_add_f32 v129, v129, v131
    v_add_f32 v128, v128, v129
    v_cvt_pk_bf16_f32 v130, v128, v128
    v_and_b32 v130, 0xffff0000, v130
    v_sub_f32 v128, v128, v130
    v_cvt_pk_bf16_f32 v128, v128, v130
    v_mov_b32 v129, s11
    buffer_store_dwordx2 v[128:129], v8, s[56:59], s86 offen offset:0 sc1
L_hr0:
    s_waitcnt vmcnt(6)
    v_dot2_f32_bf16 v112, v76, s83, 0
    v_dot2_f32_bf16 v113, v76, s84, 0
    v_dot2_f32_bf16 v114, v77, s83, 0
    v_dot2_f32_bf16 v115, v77, s84, 0
    v_dot2_f32_bf16 v116, v78, s83, 0
    v_dot2_f32_bf16 v117, v78, s84, 0
    v_dot2_f32_bf16 v118, v79, s83, 0
    v_dot2_f32_bf16 v119, v79, s84, 0
    s_waitcnt vmcnt(5)
    v_dot2_f32_bf16 v112, v80, s83, v112
    v_dot2_f32_bf16 v113, v80, s84, v113
    v_dot2_f32_bf16 v114, v81, s83, v114
    v_dot2_f32_bf16 v115, v81, s84, v115
    v_dot2_f32_bf16 v116, v82, s83, v116
    v_dot2_f32_bf16 v117, v82, s84, v117
    v_dot2_f32_bf16 v118, v83, s83, v118
    v_dot2_f32_bf16 v119, v83, s84, v119
    s_waitcnt vmcnt(4)
    v_dot2_f32_bf16 v112, v84, s83, v112
    v_dot2_f32_bf16 v113, v84, s84, v113
    v_dot2_f32_bf16 v114, v85, s83, v114
    v_dot2_f32_bf16 v115, v85, s84, v115
    v_dot2_f32_bf16 v116, v86, s83, v116
    v_dot2_f32_bf16 v117, v86, s84, v117
    v_dot2_f32_bf16 v118, v87, s83, v118
    v_dot2_f32_bf16 v119, v87, s84, v119
    s_waitcnt vmcnt(3)
    v_dot2_f32_bf16 v112, v88, s83, v112
    v_dot2_f32_bf16 v113, v88, s84, v113
    v_dot2_f32_bf16 v114, v89, s83, v114
    v_dot2_f32_bf16 v115, v89, s84, v115
    v_dot2_f32_bf16 v116, v90, s83, v116
    v_dot2_f32_bf16 v117, v90, s84, v117
    v_dot2_f32_bf16 v118, v91, s83, v118
    v_dot2_f32_bf16 v119, v91, s84, v119
    s_waitcnt vmcnt(2)
    v_dot2_f32_bf16 v112, v92, s83, v112
    v_dot2_f32_bf16 v113, v92, s84, v113
    v_dot2_f32_bf16 v114, v93, s83, v114
    v_dot2_f32_bf16 v115, v93, s84, v115
    v_dot2_f32_bf16 v116, v94, s83, v116
    v_dot2_f32_bf16 v117, v94, s84, v117
    v_dot2_f32_bf16 v118, v95, s83, v118
    v_dot2_f32_bf16 v119, v95, s84, v119
    s_waitcnt vmcnt(1)
    v_dot2_f32_bf16 v112, v96, s83, v112
    v_dot2_f32_bf16 v113, v96, s84, v113
    v_dot2_f32_bf16 v114, v97, s83, v114
    v_dot2_f32_bf16 v115, v97, s84, v115
    v_dot2_f32_bf16 v116, v98, s83, v116
    v_dot2_f32_bf16 v117, v98, s84, v117
    v_dot2_f32_bf16 v118, v99, s83, v118
    v_dot2_f32_bf16 v119, v99, s84, v119
    s_waitcnt vmcnt(0)
    v_dot2_f32_bf16 v112, v100, s83, v112
    v_dot2_f32_bf16 v113, v100, s84, v113
    v_dot2_f32_bf16 v114, v101, s83, v114
    v_dot2_f32_bf16 v115, v101, s84, v115
    v_dot2_f32_bf16 v116, v102, s83, v116
    v_dot2_f32_bf16 v117, v102, s84, v117
    v_dot2_f32_bf16 v118, v103, s83, v118
    v_dot2_f32_bf16 v119, v103, s84, v119
    ds_write_b128 v4, v[112:115] offset:16384
    s_nop 1
    ds_write_b128 v4, v[116:119] offset:16400
    s_waitcnt lgkmcnt(0)
    s_barrier
    s_cmp_lg_u32 s3, 6
    s_cbranch_scc1 L_hr1
    s_cmp_ge_u32 s5, 14
    s_cbranch_scc1 L_hr1
    ds_read2st64_b32 v[128:129], v5 offset0:64 offset1:65
    ds_read2st64_b32 v[130:131], v5 offset0:66 offset1:67
    ds_read2st64_b32 v[132:133], v5 offset0:68 offset1:69
    ds_read2st64_b32 v[134:135], v5 offset0:70 offset1:71
    ds_read2st64_b32 v[136:137], v5 offset0:72 offset1:73
    ds_read2st64_b32 v[138:139], v5 offset0:74 offset1:75
    ds_read2st64_b32 v[140:141], v5 offset0:76 offset1:77
    ds_read2st64_b32 v[142:143], v5 offset0:78 offset1:79
    ds_read2st64_b32 v[144:145], v5 offset0:80 offset1:81
    ds_read2st64_b32 v[146:147], v5 offset0:82 offset1:83
    ds_read2st64_b32 v[148:149], v5 offset0:84 offset1:85
    ds_read2st64_b32 v[150:151], v5 offset0:86 offset1:87
    s_waitcnt lgkmcnt(0)
    ds_read2st64_b32 v[152:153], v5 offset0:88 offset1:89
    ds_read2st64_b32 v[154:155], v5 offset0:90 offset1:91
    ds_read2st64_b32 v[156:157], v5 offset0:92 offset1:93
    ds_read2st64_b32 v[158:159], v5 offset0:94 offset1:95
    ds_read2st64_b32 v[160:161], v5 offset0:96 offset1:97
    ds_read2st64_b32 v[162:163], v5 offset0:98 offset1:99
    ds_read2st64_b32 v[164:165], v5 offset0:100 offset1:101
    ds_read2st64_b32 v[166:167], v5 offset0:102 offset1:103
    ds_read2st64_b32 v[168:169], v5 offset0:104 offset1:105
    ds_read2st64_b32 v[170:171], v5 offset0:106 offset1:107
    ds_read2st64_b32 v[172:173], v5 offset0:108 offset1:109
    ds_read2st64_b32 v[174:175], v5 offset0:110 offset1:111
    s_waitcnt lgkmcnt(0)
    ds_read2st64_b32 v[176:177], v5 offset0:112 offset1:113
    ds_read2st64_b32 v[178:179], v5 offset0:114 offset1:115
    ds_read2st64_b32 v[180:181], v5 offset0:116 offset1:117
    ds_read2st64_b32 v[182:183], v5 offset0:118 offset1:119
    ds_read2st64_b32 v[184:185], v5 offset0:120 offset1:121
    ds_read2st64_b32 v[186:187], v5 offset0:122 offset1:123
    ds_read2st64_b32 v[188:189], v5 offset0:124 offset1:125
    ds_read2st64_b32 v[190:191], v5 offset0:126 offset1:127
    s_waitcnt lgkmcnt(0)
    v_add_f32 v128, v128, v160
    v_add_f32 v129, v129, v161
    v_add_f32 v130, v130, v162
    v_add_f32 v131, v131, v163
    v_add_f32 v132, v132, v164
    v_add_f32 v133, v133, v165
    v_add_f32 v134, v134, v166
    v_add_f32 v135, v135, v167
    v_add_f32 v136, v136, v168
    v_add_f32 v137, v137, v169
    v_add_f32 v138, v138, v170
    v_add_f32 v139, v139, v171
    v_add_f32 v140, v140, v172
    v_add_f32 v141, v141, v173
    v_add_f32 v142, v142, v174
    v_add_f32 v143, v143, v175
    v_add_f32 v144, v144, v176
    v_add_f32 v145, v145, v177
    v_add_f32 v146, v146, v178
    v_add_f32 v147, v147, v179
    v_add_f32 v148, v148, v180
    v_add_f32 v149, v149, v181
    v_add_f32 v150, v150, v182
    v_add_f32 v151, v151, v183
    v_add_f32 v152, v152, v184
    v_add_f32 v153, v153, v185
    v_add_f32 v154, v154, v186
    v_add_f32 v155, v155, v187
    v_add_f32 v156, v156, v188
    v_add_f32 v157, v157, v189
    v_add_f32 v158, v158, v190
    v_add_f32 v159, v159, v191
    v_add_f32 v128, v128, v144
    v_add_f32 v129, v129, v145
    v_add_f32 v130, v130, v146
    v_add_f32 v131, v131, v147
    v_add_f32 v132, v132, v148
    v_add_f32 v133, v133, v149
    v_add_f32 v134, v134, v150
    v_add_f32 v135, v135, v151
    v_add_f32 v136, v136, v152
    v_add_f32 v137, v137, v153
    v_add_f32 v138, v138, v154
    v_add_f32 v139, v139, v155
    v_add_f32 v140, v140, v156
    v_add_f32 v141, v141, v157
    v_add_f32 v142, v142, v158
    v_add_f32 v143, v143, v159
    v_add_f32 v128, v128, v136
    v_add_f32 v129, v129, v137
    v_add_f32 v130, v130, v138
    v_add_f32 v131, v131, v139
    v_add_f32 v132, v132, v140
    v_add_f32 v133, v133, v141
    v_add_f32 v134, v134, v142
    v_add_f32 v135, v135, v143
    v_add_f32 v128, v128, v132
    v_add_f32 v129, v129, v133
    v_add_f32 v130, v130, v134
    v_add_f32 v131, v131, v135
    v_add_f32 v128, v128, v130
    v_add_f32 v129, v129, v131
    v_add_f32 v128, v128, v129
    v_cvt_pk_bf16_f32 v130, v128, v128
    v_and_b32 v130, 0xffff0000, v130
    v_sub_f32 v128, v128, v130
    v_cvt_pk_bf16_f32 v128, v128, v130
    v_mov_b32 v129, s11
    buffer_store_dwordx2 v[128:129], v8, s[56:59], s86 offen offset:512 sc1
L_hr1:
    s_mov_b32 s60, s26
    s_and_b32 s61, s27, 0xffff
    s_mov_b32 s62, 401408
    s_mov_b32 s63, 0x20000
    s_mov_b32 s64, s28
    s_and_b32 s65, s29, 0xffff
    s_mov_b32 s66, 401408
    s_mov_b32 s67, 0x20000
    s_mov_b32 s68, s40
    s_and_b32 s69, s41, 0xffff
    s_mov_b32 s70, 1605632
    s_mov_b32 s71, 0x20000
    s_lshl_b32 s12, s8, 3
    s_add_u32 s12, s12, s3
    s_lshl_b32 s13, s12, 13
    s_lshl_b32 s12, s12, 11
    v_lshl_add_u32 v200, v1, 7, s13
    v_lshl_add_u32 v201, v1, 5, s12
    buffer_load_dword v202, v201, s[60:63], 0 offen
    buffer_load_dword v203, v201, s[64:67], 0 offen
    buffer_load_dword v204, v200, s[68:71], 0 offen
    s_waitcnt vmcnt(0)
    s_cmp_ge_u32 s3, 7
    s_cbranch_scc1 L_hdone
    s_lshl_b32 s12, s9, 2
    s_add_u32 s12, s12, s10
    s_lshl_b32 s13, s12, 8
    s_lshl_b32 s14, s3, 3
    s_add_u32 s13, s13, s14
    s_lshl_b32 s13, s13, 6
    s_add_u32 s13, s13, 12582912
    v_and_b32 v4, 1, v1
    v_lshlrev_b32 v4, 2, v4
    v_bfe_u32 v5, v1, 1, 1
    v_lshl_add_u32 v4, v5, 7, v4
    v_lshlrev_b32 v4, 6, v4
    s_mul_i32 s12, s12, 114688
    v_and_b32 v5, 31, v1
    v_lshlrev_b32 v5, 7, v5
    v_lshrrev_b32 v6, 5, v1
    s_lshl_b32 s14, s3, 1
    v_add_u32 v6, s14, v6
    v_lshl_add_u32 v7, v6, 12, v5
    v_lshl_add_u32 v6, v6, 13, v5
    s_add_u32 s14, s13, 0
    s_mov_b32 s99, 0
L_hpS:
    s_sleep 4
    buffer_load_dword v8, v4, s[56:59], s14 offen sc1
    s_waitcnt vmcnt(0)
    v_cmp_ne_u32 vcc, s11, v8
    s_cbranch_vccz L_hpS_ok
    s_add_u32 s99, s99, 1
    s_cmp_lt_u32 s99, 200
    s_cbranch_scc1 L_hpS
    s_branch L_hdone
L_hpS_ok:
    s_add_u32 s14, s12, 0
    s_add_u32 s15, s14, 57344
    buffer_load_dword v9, v7, s[56:59], s14 offen
    buffer_load_dword v10, v7, s[56:59], s15 offen
    s_waitcnt vmcnt(0)
L_hdone:
    s_endpgm
L_ggm_slow:
    s_mov_b32 s99, 0
L_ggm_loop:
    s_sleep 4
    buffer_load_dwordx2 v[228:229], v238, s[68:71], s92 offen sc1
    s_waitcnt vmcnt(0)
    v_cmp_ne_u32 vcc, s11, v229
    s_cbranch_vccz L_ggm_ok
    s_add_u32 s99, s99, 1
    s_cmp_lt_u32 s99, 262144
    s_cbranch_scc1 L_ggm_loop
    s_branch L_ggm_ok
L_gfa_slow:
    s_mov_b32 s99, 0
L_gfa_loop:
    s_sleep 4
    buffer_load_dword v8, v7, s[68:71], s91 offen sc1
    s_waitcnt vmcnt(0)
    v_cmp_ne_u32 vcc, s11, v8
    s_cbranch_vccz L_gfa_ok
    s_add_u32 s99, s99, 1
    s_cmp_lt_u32 s99, 262144
    s_cbranch_scc1 L_gfa_loop
    s_branch L_gfa_ok
L_gl1_slow:
    s_mov_b32 s99, 0
L_gl1_loop:
    s_sleep 2
    ds_read_b32 v206, v14 offset:1024
    s_waitcnt lgkmcnt(0)
    v_cmp_gt_u32 vcc, 1, v206
    s_cbranch_vccz L_gl1_ok
    s_add_u32 s99, s99, 1
    s_cmp_lt_u32 s99, 2097152
    s_cbranch_scc1 L_gl1_loop
    s_branch L_gl1_ok
L_gfb_slow:
    s_mov_b32 s99, 0
L_gfb_loop:
    s_sleep 4
    buffer_load_dword v8, v7, s[68:71], s89 offen sc1
    s_waitcnt vmcnt(0)
    v_cmp_ne_u32 vcc, s11, v8
    s_cbranch_vccz L_gfb_ok
    s_add_u32 s99, s99, 1
    s_cmp_lt_u32 s99, 262144
    s_cbranch_scc1 L_gfb_loop
    s_branch L_gfb_ok
L_gl9_slow:
    s_mov_b32 s99, 0
L_gl9_loop:
    s_sleep 2
    ds_read_b32 v206, v14 offset:1024
    s_waitcnt lgkmcnt(0)
    v_cmp_gt_u32 vcc, 2, v206
    s_cbranch_vccz L_gl9_ok
    s_add_u32 s99, s99, 1
    s_cmp_lt_u32 s99, 2097152
    s_cbranch_scc1 L_gl9_loop
    s_branch L_gl9_ok
L_gp2_slow:
    s_mov_b32 s99, 0
L_gp2_loop:
    s_sleep 2
    ds_read_b32 v204, v14 offset:0
    s_waitcnt lgkmcnt(0)
    v_cmp_gt_u32 vcc, 3, v204
    s_cbranch_vccz L_gp2_ok
    s_add_u32 s99, s99, 1
    s_cmp_lt_u32 s99, 2097152
    s_cbranch_scc1 L_gp2_loop
    s_branch L_gp2_ok
L_scs_slow:
    s_mov_b32 s99, 0
L_scs_loop:
    s_sleep 4
    buffer_load_dwordx2 v[120:121], v13, s[68:71], s14 offen offset:0 sc1
    buffer_load_dwordx2 v[124:125], v13, s[68:71], s14 offen offset:3584 sc1
    buffer_load_dwordx4 v[216:219], v244, s[68:71], s93 offen sc1
    s_waitcnt vmcnt(0)
    v_xor_b32 v186, s11, v121
    v_xor_b32 v187, s11, v125
    v_or_b32 v186, v186, v187
    v_xor_b32 v187, s11, v217
    v_or_b32 v186, v186, v187
    v_xor_b32 v187, s11, v219
    v_or_b32 v186, v186, v187
    v_cmp_ne_u32 vcc, 0, v186
    s_cbranch_vccz L_scs_ok
    s_add_u32 s99, s99, 1
    s_cmp_lt_u32 s99, 262144
    s_cbranch_scc1 L_scs_loop
    s_branch L_scs_ok
L_ag_slow:
    s_mov_b32 s99, 0
L_ag_loop:
    s_sleep 2
    buffer_load_dwordx4 v[192:195], v232, s[52:55], 0 offen sc1
    buffer_load_dwordx4 v[196:199], v233, s[52:55], 0 offen sc1
    s_waitcnt vmcnt(0)
    v_add_u32 v188, v193, v195
    v_add3_u32 v188, v188, v197, v199
    v_cmp_ne_u32 vcc, v224, v188
    s_cbranch_vccz L_ag_ok
    s_add_u32 s99, s99, 1
    s_cmp_lt_u32 s99, 262144
    s_cbranch_scc1 L_ag_loop
    s_branch L_ag_ok
L_scw0_slow:
    s_mov_b32 s99, 0
L_scw0_loop:
    s_sleep 4
    buffer_load_dwordx2 v[240:241], v242, s[68:71], s92 offen offset:0 sc1
    s_waitcnt vmcnt(0)
    v_cmp_ne_u32 vcc, s11, v241
    s_cbranch_vccz L_scw0_ok
    s_add_u32 s99, s99, 1
    s_cmp_lt_u32 s99, 262144
    s_cbranch_scc1 L_scw0_loop
    s_branch L_scw0_ok
L_scw1_slow:
    s_mov_b32 s99, 0
L_scw1_loop:
    s_sleep 4
    buffer_load_dwordx2 v[240:241], v242, s[68:71], s92 offen offset:512 sc1
    s_waitcnt vmcnt(0)
    v_cmp_ne_u32 vcc, s11, v241
    s_cbranch_vccz L_scw1_ok
    s_add_u32 s99, s99, 1
    s_cmp_lt_u32 s99, 262144
    s_cbranch_scc1 L_scw1_loop
    s_branch L_scw1_ok
L_sp1_slow:
    s_mov_b32 s99, 0
L_sp1_loop:
    s_sleep 2
    ds_read_b32 v2, v11 offset:0
    s_waitcnt lgkmcnt(0)
    v_cmp_gt_u32 vcc, 1, v2
    s_cbranch_vccz L_sp1_ok
    s_add_u32 s99, s99, 1
    s_cmp_lt_u32 s99, 2097152
    s_cbranch_scc1 L_sp1_loop
    s_branch L_sp1_ok
L_slate:
    s_waitcnt vmcnt(0)
    v_mov_b32 v13, 1
    ds_write_b32 v8, v13
    s_mov_b32 s99, 0
L_slate_loop:
    buffer_load_dword v14, v225, s[68:71], s90 offen sc1
    s_waitcnt vmcnt(0)
    v_cmp_ne_u32 vcc, s11, v14
    s_cbranch_vccz L_slate_ok
    s_sleep 4
    s_add_u32 s99, s99, 1
    s_cmp_lt_u32 s99, 262144
    s_cbranch_scc1 L_slate_loop
L_slate_ok:
    s_add_u32 s92, s91, 0
    s_add_u32 s93, s92, 57344
    buffer_load_dwordx4 v[192:195], v12, s[68:71], s92 offen offset:0 sc1
    buffer_load_dwordx4 v[196:199], v12, s[68:71], s93 offen offset:0 sc1
    buffer_load_dwordx4 v[200:203], v12, s[68:71], s92 offen offset:1024 sc1
    buffer_load_dwordx4 v[204:207], v12, s[68:71], s93 offen offset:1024 sc1
    s_add_u32 s92, s91, 8192
    s_add_u32 s93, s92, 57344
    buffer_load_dwordx4 v[208:211], v12, s[68:71], s92 offen offset:0 sc1
    buffer_load_dwordx4 v[212:215], v12, s[68:71], s93 offen offset:0 sc1
    buffer_load_dwordx4 v[216:219], v12, s[68:71], s92 offen offset:1024 sc1
    buffer_load_dwordx4 v[220:223], v12, s[68:71], s93 offen offset:1024 sc1
    s_add_u32 s92, s91, 16384
    s_add_u32 s93, s92, 57344
    buffer_load_dwordx4 v[224:227], v12, s[68:71], s92 offen offset:0 sc1
    buffer_load_dwordx4 v[228:231], v12, s[68:71], s93 offen offset:0 sc1
    buffer_load_dwordx4 v[232:235], v12, s[68:71], s92 offen offset:1024 sc1
    buffer_load_dwordx4 v[236:239], v12, s[68:71], s93 offen offset:1024 sc1
    s_add_u32 s92, s91, 24576
    s_add_u32 s93, s92, 57344
    buffer_load_dwordx4 v[240:243], v12, s[68:71], s92 offen offset:0 sc1
    buffer_load_dwordx4 v[244:247], v12, s[68:71], s93 offen offset:0 sc1
    buffer_load_dwordx4 v[248:251], v12, s[68:71], s92 offen offset:1024 sc1
    buffer_load_dwordx4 v[252:255], v12, s[68:71], s93 offen offset:1024 sc1
    s_branch L_sjoin
L_sp2_slow:
    s_mov_b32 s99, 0
L_sp2_loop:
    s_sleep 2
    ds_read_b32 v2, v11 offset:0
    s_waitcnt lgkmcnt(0)
    v_cmp_gt_u32 vcc, 2, v2
    s_cbranch_vccz L_sp2_ok
    s_add_u32 s99, s99, 1
    s_cmp_lt_u32 s99, 2097152
    s_cbranch_scc1 L_sp2_loop
    s_branch L_sp2_ok
L_ssd_slow:
    s_mov_b32 s99, 0
L_ssd_loop:
    s_sleep 2
    ds_read_b32 v2, v11 offset:1024
    s_waitcnt lgkmcnt(0)
    v_cmp_gt_u32 vcc, 3, v2
    s_cbranch_vccz L_ssd_ok
    s_add_u32 s99, s99, 1
    s_cmp_lt_u32 s99, 2097152
    s_cbranch_scc1 L_ssd_loop
    s_branch L_ssd_ok
L_end:
    s_endpgm
.if (. - recurrent_scan__ssm_conv_s5__glu_gated_bilinear__prompt_kernel) < 0x8080
.fill (0x8080 - (. - recurrent_scan__ssm_conv_s5__glu_gated_bilinear__prompt_kernel)) >> 2, 4, 0xbf810000
.endif
.section .rodata,"a"
.p2align 6
.amdhsa_kernel recurrent_scan__ssm_conv_s5__glu_gated_bilinear__prompt_kernel
  .amdhsa_next_free_vgpr 256
  .amdhsa_next_free_sgpr 102
  .amdhsa_accum_offset 256
  .amdhsa_group_segment_fixed_size 0
  .amdhsa_kernarg_size 128
  .amdhsa_user_sgpr_count 2
  .amdhsa_user_sgpr_kernarg_segment_ptr 1
  .amdhsa_system_sgpr_workgroup_id_x 1
.end_amdhsa_kernel
```
